```python
import torch

def _softmax(x, axis=-1):
    return torch.softmax(x, dim=axis)
def _gelu(x):
    return torch.nn.functional.gelu(x, approximate="tanh")
def _silu(x):
    return torch.nn.functional.silu(x)
def _sigmoid(x):
    return torch.sigmoid(x)
def _layernorm(x, axis=-1, eps=1e-5):
    m = x.mean(dim=axis, keepdim=True)
    v = x.var(dim=axis, keepdim=True, unbiased=False)
    return (x - m) / torch.sqrt(v + eps)
def _scatter_add(tgt, idx, src, axis=0):
    return tgt.clone().index_add_(axis, idx, src)
def _segment_sum(src, seg, n):
    out = torch.zeros((n,) + src.shape[1:], dtype=src.dtype)
    return out.index_add_(0, seg, src)
def _pad(x, pw):
    flat = tuple(v for pair in reversed(pw) for v in pair)
    return torch.nn.functional.pad(x, flat)

kernel_name = 'recurrent_scan__mha_block_cached__glu_gated_swiglu__decode'

def setup_inputs():

    _w = (lambda a: (lambda t: t.to(torch.bfloat16) if t.is_floating_point() else t)(torch.as_tensor(a)))
    def _A_setup():
        B, Sq, D = 1, 1, 640
        H, Sk, Dh = 32, 32768, 192
        return {
            "x": _w((lambda *s: torch.randn(*s, dtype=torch.bfloat16) * 0.2)(B, Sq, D)),
            "k_cache": _w((lambda *s: torch.randn(*s, dtype=torch.bfloat16) * 1.6)(B, H, Sk, Dh)),
            "v_cache": _w((lambda *s: torch.randn(*s, dtype=torch.bfloat16) * 1.6)(B, H, Sk, Dh)),
            "wq": _w((lambda *s: torch.randn(*s, dtype=torch.bfloat16) * 1.6)(D, H * Dh) * (D ** -0.5)),
            "wo": _w((lambda *s: torch.randn(*s, dtype=torch.bfloat16) * 1.6)(H * Dh, D) * ((H * Dh) ** -0.5)),
        }
    _A_in = _A_setup()

    def _B_setup():
        B, S, D, F = 1, 1, 640, 1536
        return {
            "x": _w((lambda *s: torch.randn(*s, dtype=torch.bfloat16) * 0.2)(B, S, D)),
            "w1": _w((lambda *s: torch.randn(*s, dtype=torch.bfloat16) * 0.8)(D, F) * (2.0 / D) ** 0.5),
            "w3": _w((lambda *s: torch.randn(*s, dtype=torch.bfloat16) * 0.8)(D, F) * (2.0 / D) ** 0.5),
            "w2": _w((lambda *s: torch.randn(*s, dtype=torch.bfloat16) * 0.8)(F, D) * (2.0 / F) ** 0.5),
        }
    _B_in = _B_setup()

    return {
        "A_x": _A_in["x"],
        "A_k_cache": _A_in["k_cache"],
        "A_v_cache": _A_in["v_cache"],
        "A_wq": _A_in["wq"],
        "A_wo": _A_in["wo"],
        "B_x": _B_in["x"],
        "B_w1": _B_in["w1"],
        "B_w3": _B_in["w3"],
        "B_w2": _B_in["w2"],
    }

def reference(A_x, A_k_cache, A_v_cache, A_wq, A_wo, B_x, B_w1, B_w3, B_w2):
    def _A_ref(x, k_cache, v_cache, wq, wo):
        B, Sq, D = x.shape
        H, Dh = 32, 192
        q = (lambda x, *d: x.permute(*d))((x @ wq).reshape(B, Sq, H, Dh), 0, 2, 1, 3)
        scores = torch.einsum("bhqd,bhkd->bhqk", q, k_cache) * (Dh ** -0.5)
        p = _softmax(scores, axis=-1)
        o = torch.einsum("bhqk,bhkd->bhqd", p, v_cache)
        return (lambda x, *d: x.permute(*d))(o, 0, 2, 1, 3).reshape(B, Sq, H * Dh) @ wo

    def _B_ref(x, w1, w3, w2):
        gate = torch.einsum("bsd,df->bsf", x, w1)
        up = torch.einsum("bsd,df->bsf", x, w3)
        h = _silu(gate) * up
        out = torch.einsum("bsf,fd->bsd", h, w2)
        return out

    x = A_x
    xn = _layernorm(x, axis=-1)
    s = _A_ref(xn, A_k_cache, A_v_cache, A_wq, A_wo)
    g = _silu(_B_ref(xn, B_w1, B_w3, B_w2))
    return x + s * g
```

```asm
; @launch kernel=prep_kernel grid=(144,1,1) block=(256,1,1) lds=18432
; @launch kernel=attn_kernel grid=(512,1,1) block=(256,1,1) lds=24832
; @launch kernel=proj_kernel grid=(160,1,1) block=(256,1,1) lds=7936
; @launch kernel=final_kernel grid=(10,1,1) block=(256,1,1) lds=2048
.amdgcn_target "amdgcn-amd-amdhsa--gfx950"
.text
.globl prep_kernel
.p2align 8
.type prep_kernel,@function
prep_kernel:
  s_cmp_ge_u32 s2, 144
  s_cbranch_scc1 K1_END
  s_load_dwordx2 s[4:5], s[0:1], 0
  s_load_dwordx2 s[6:7], s[0:1], 24
  s_load_dwordx4 s[8:11], s[0:1], 48
  s_load_dwordx2 s[12:13], s[0:1], 88
  s_waitcnt lgkmcnt(0)
  s_mov_b32 s14, s6
  s_mov_b32 s15, s7
  s_mov_b32 s20, 12288
  s_lshl_b32 s21, s2, 6
  s_mov_b32 s22, s21
  s_cmp_lt_u32 s2, 96
  s_cbranch_scc1 K1_SEL
  s_mov_b32 s14, s8
  s_mov_b32 s15, s9
  s_mov_b32 s20, 3072
  s_sub_u32 s21, s2, 96
  s_lshl_b32 s21, s21, 6
  s_add_u32 s22, s21, 6144
  s_cmp_lt_u32 s2, 120
  s_cbranch_scc1 K1_SEL
  s_mov_b32 s14, s10
  s_mov_b32 s15, s11
  s_sub_u32 s21, s2, 120
  s_lshl_b32 s21, s21, 6
  s_add_u32 s22, s21, 7680
K1_SEL:
  s_mul_i32 s23, s20, 640
  s_mov_b32 s16, s14
  s_and_b32 s17, s15, 0xffff
  s_mov_b32 s18, s23
  s_mov_b32 s19, 0x00020000
  s_mov_b32 s24, s4
  s_and_b32 s25, s5, 0xffff
  s_mov_b32 s26, 1280
  s_mov_b32 s27, 0x00020000
  s_mov_b32 s28, s12
  s_and_b32 s29, s13, 0xffff
  s_mov_b32 s30, 1610612736
  s_mov_b32 s31, 0x00020000
  v_and_b32 v1, 63, v0
  v_lshrrev_b32 v2, 6, v0
  v_lshrrev_b32 v3, 3, v1
  v_and_b32 v4, 7, v1
  v_lshl_add_u32 v5, v2, 3, v3
  v_mul_lo_u32 v6, v5, s20
  v_lshlrev_b32 v7, 4, v4
  s_lshl_b32 s3, s21, 1
  v_add3_u32 v6, v6, v7, s3
  s_lshl_b32 s32, s20, 5
  s_mov_b32 s33, 0
  v_lshlrev_b32 v8, 2, v1
  buffer_load_dword v100, v8, s[24:27], 0 offen offset:0
  buffer_load_dword v101, v8, s[24:27], 0 offen offset:256
  buffer_load_dword v102, v8, s[24:27], 0 offen offset:512
  buffer_load_dword v103, v8, s[24:27], 0 offen offset:768
  buffer_load_dword v104, v8, s[24:27], 0 offen offset:1024
  buffer_load_dwordx4 v[16:19], v6, s[16:19], s33 offen
  s_add_u32 s33, s33, s32
  buffer_load_dwordx4 v[20:23], v6, s[16:19], s33 offen
  s_add_u32 s33, s33, s32
  buffer_load_dwordx4 v[24:27], v6, s[16:19], s33 offen
  s_add_u32 s33, s33, s32
  buffer_load_dwordx4 v[28:31], v6, s[16:19], s33 offen
  s_add_u32 s33, s33, s32
  buffer_load_dwordx4 v[32:35], v6, s[16:19], s33 offen
  s_add_u32 s33, s33, s32
  buffer_load_dwordx4 v[36:39], v6, s[16:19], s33 offen
  s_add_u32 s33, s33, s32
  buffer_load_dwordx4 v[40:43], v6, s[16:19], s33 offen
  s_add_u32 s33, s33, s32
  buffer_load_dwordx4 v[44:47], v6, s[16:19], s33 offen
  s_add_u32 s33, s33, s32
  buffer_load_dwordx4 v[48:51], v6, s[16:19], s33 offen
  s_add_u32 s33, s33, s32
  buffer_load_dwordx4 v[52:55], v6, s[16:19], s33 offen
  s_add_u32 s33, s33, s32
  buffer_load_dwordx4 v[56:59], v6, s[16:19], s33 offen
  s_add_u32 s33, s33, s32
  buffer_load_dwordx4 v[60:63], v6, s[16:19], s33 offen
  s_add_u32 s33, s33, s32
  buffer_load_dwordx4 v[64:67], v6, s[16:19], s33 offen
  s_add_u32 s33, s33, s32
  buffer_load_dwordx4 v[68:71], v6, s[16:19], s33 offen
  s_add_u32 s33, s33, s32
  buffer_load_dwordx4 v[72:75], v6, s[16:19], s33 offen
  s_add_u32 s33, s33, s32
  buffer_load_dwordx4 v[76:79], v6, s[16:19], s33 offen
  s_add_u32 s33, s33, s32
  buffer_load_dwordx4 v[80:83], v6, s[16:19], s33 offen
  s_add_u32 s33, s33, s32
  buffer_load_dwordx4 v[84:87], v6, s[16:19], s33 offen
  s_add_u32 s33, s33, s32
  buffer_load_dwordx4 v[88:91], v6, s[16:19], s33 offen
  s_add_u32 s33, s33, s32
  buffer_load_dwordx4 v[92:95], v6, s[16:19], s33 offen
  s_waitcnt vmcnt(20)
  s_mov_b32 s34, 0xffff0000
  v_lshlrev_b32 v110, 16, v100
  v_and_b32 v111, s34, v100
  v_lshlrev_b32 v112, 16, v101
  v_and_b32 v113, s34, v101
  v_lshlrev_b32 v114, 16, v102
  v_and_b32 v115, s34, v102
  v_lshlrev_b32 v116, 16, v103
  v_and_b32 v117, s34, v103
  v_lshlrev_b32 v118, 16, v104
  v_and_b32 v119, s34, v104
  v_add_f32 v9, v110, v111
  v_add_f32 v9, v9, v112
  v_add_f32 v9, v9, v113
  v_add_f32 v9, v9, v114
  v_add_f32 v9, v9, v115
  v_add_f32 v9, v9, v116
  v_add_f32 v9, v9, v117
  v_add_f32 v9, v9, v118
  v_add_f32 v9, v9, v119
  s_nop 1
  v_add_f32_dpp v9, v9, v9 quad_perm:[1,0,3,2] row_mask:0xf bank_mask:0xf
  s_nop 1
  v_add_f32_dpp v9, v9, v9 quad_perm:[2,3,0,1] row_mask:0xf bank_mask:0xf
  s_nop 1
  v_add_f32_dpp v9, v9, v9 row_half_mirror row_mask:0xf bank_mask:0xf
  s_nop 1
  v_add_f32_dpp v9, v9, v9 row_mirror row_mask:0xf bank_mask:0xf
  s_nop 1
  v_readlane_b32 s36, v9, 0
  v_readlane_b32 s37, v9, 16
  v_readlane_b32 s38, v9, 32
  v_readlane_b32 s39, v9, 48
  s_nop 3
  v_mov_b32 v9, s36
  v_add_f32 v9, s37, v9
  v_add_f32 v9, s38, v9
  v_add_f32 v9, s39, v9
  v_mul_f32 v9, 0x3acccccd, v9
  v_sub_f32 v10, v110, v9
  v_mul_f32 v11, v10, v10
  v_sub_f32 v10, v111, v9
  v_fmac_f32 v11, v10, v10
  v_sub_f32 v10, v112, v9
  v_fmac_f32 v11, v10, v10
  v_sub_f32 v10, v113, v9
  v_fmac_f32 v11, v10, v10
  v_sub_f32 v10, v114, v9
  v_fmac_f32 v11, v10, v10
  v_sub_f32 v10, v115, v9
  v_fmac_f32 v11, v10, v10
  v_sub_f32 v10, v116, v9
  v_fmac_f32 v11, v10, v10
  v_sub_f32 v10, v117, v9
  v_fmac_f32 v11, v10, v10
  v_sub_f32 v10, v118, v9
  v_fmac_f32 v11, v10, v10
  v_sub_f32 v10, v119, v9
  v_fmac_f32 v11, v10, v10
  s_nop 1
  v_add_f32_dpp v11, v11, v11 quad_perm:[1,0,3,2] row_mask:0xf bank_mask:0xf
  s_nop 1
  v_add_f32_dpp v11, v11, v11 quad_perm:[2,3,0,1] row_mask:0xf bank_mask:0xf
  s_nop 1
  v_add_f32_dpp v11, v11, v11 row_half_mirror row_mask:0xf bank_mask:0xf
  s_nop 1
  v_add_f32_dpp v11, v11, v11 row_mirror row_mask:0xf bank_mask:0xf
  s_nop 1
  v_readlane_b32 s36, v11, 0
  v_readlane_b32 s37, v11, 16
  v_readlane_b32 s38, v11, 32
  v_readlane_b32 s39, v11, 48
  s_nop 3
  v_mov_b32 v11, s36
  v_add_f32 v11, s37, v11
  v_add_f32 v11, s38, v11
  v_add_f32 v11, s39, v11
  v_mul_f32 v11, 0x3acccccd, v11
  v_cvt_pk_bf16_f32 v12, v9, v9
  v_lshlrev_b32 v9, 16, v12
  v_cvt_pk_bf16_f32 v12, v11, v11
  v_lshlrev_b32 v11, 16, v12
  v_add_f32 v11, 0x3727c5ac, v11
  v_cvt_pk_bf16_f32 v12, v11, v11
  v_lshlrev_b32 v11, 16, v12
  v_sqrt_f32 v11, v11
  s_nop 0
  v_cvt_pk_bf16_f32 v12, v11, v11
  v_lshlrev_b32 v11, 16, v12
  v_rcp_f32 v11, v11
  s_nop 0
  v_sub_f32 v110, v110, v9
  v_cvt_pk_bf16_f32 v12, v110, v110
  v_lshlrev_b32 v110, 16, v12
  v_mul_f32 v110, v110, v11
  v_cvt_pk_bf16_f32 v12, v110, v110
  v_lshlrev_b32 v110, 16, v12
  v_sub_f32 v111, v111, v9
  v_cvt_pk_bf16_f32 v12, v111, v111
  v_lshlrev_b32 v111, 16, v12
  v_mul_f32 v111, v111, v11
  v_cvt_pk_bf16_f32 v12, v111, v111
  v_lshlrev_b32 v111, 16, v12
  v_sub_f32 v112, v112, v9
  v_cvt_pk_bf16_f32 v12, v112, v112
  v_lshlrev_b32 v112, 16, v12
  v_mul_f32 v112, v112, v11
  v_cvt_pk_bf16_f32 v12, v112, v112
  v_lshlrev_b32 v112, 16, v12
  v_sub_f32 v113, v113, v9
  v_cvt_pk_bf16_f32 v12, v113, v113
  v_lshlrev_b32 v113, 16, v12
  v_mul_f32 v113, v113, v11
  v_cvt_pk_bf16_f32 v12, v113, v113
  v_lshlrev_b32 v113, 16, v12
  v_sub_f32 v114, v114, v9
  v_cvt_pk_bf16_f32 v12, v114, v114
  v_lshlrev_b32 v114, 16, v12
  v_mul_f32 v114, v114, v11
  v_cvt_pk_bf16_f32 v12, v114, v114
  v_lshlrev_b32 v114, 16, v12
  v_sub_f32 v115, v115, v9
  v_cvt_pk_bf16_f32 v12, v115, v115
  v_lshlrev_b32 v115, 16, v12
  v_mul_f32 v115, v115, v11
  v_cvt_pk_bf16_f32 v12, v115, v115
  v_lshlrev_b32 v115, 16, v12
  v_sub_f32 v116, v116, v9
  v_cvt_pk_bf16_f32 v12, v116, v116
  v_lshlrev_b32 v116, 16, v12
  v_mul_f32 v116, v116, v11
  v_cvt_pk_bf16_f32 v12, v116, v116
  v_lshlrev_b32 v116, 16, v12
  v_sub_f32 v117, v117, v9
  v_cvt_pk_bf16_f32 v12, v117, v117
  v_lshlrev_b32 v117, 16, v12
  v_mul_f32 v117, v117, v11
  v_cvt_pk_bf16_f32 v12, v117, v117
  v_lshlrev_b32 v117, 16, v12
  v_sub_f32 v118, v118, v9
  v_cvt_pk_bf16_f32 v12, v118, v118
  v_lshlrev_b32 v118, 16, v12
  v_mul_f32 v118, v118, v11
  v_cvt_pk_bf16_f32 v12, v118, v118
  v_lshlrev_b32 v118, 16, v12
  v_sub_f32 v119, v119, v9
  v_cvt_pk_bf16_f32 v12, v119, v119
  v_lshlrev_b32 v119, 16, v12
  v_mul_f32 v119, v119, v11
  v_cvt_pk_bf16_f32 v12, v119, v119
  v_lshlrev_b32 v119, 16, v12
  v_mul_u32_u24 v12, 2560, v2
  v_lshl_add_u32 v13, v1, 3, v12
  ds_write_b64 v13, v[110:111] offset:0
  ds_write_b64 v13, v[112:113] offset:512
  ds_write_b64 v13, v[114:115] offset:1024
  ds_write_b64 v13, v[116:117] offset:1536
  ds_write_b64 v13, v[118:119] offset:2048
  s_waitcnt lgkmcnt(0)
  v_lshl_add_u32 v13, v5, 2, v12
  ds_read_b32 v120, v13 offset:0
  ds_read_b32 v121, v13 offset:128
  ds_read_b32 v122, v13 offset:256
  ds_read_b32 v123, v13 offset:384
  ds_read_b32 v124, v13 offset:512
  ds_read_b32 v125, v13 offset:640
  ds_read_b32 v126, v13 offset:768
  ds_read_b32 v127, v13 offset:896
  ds_read_b32 v128, v13 offset:1024
  ds_read_b32 v129, v13 offset:1152
  ds_read_b32 v130, v13 offset:1280
  ds_read_b32 v131, v13 offset:1408
  ds_read_b32 v132, v13 offset:1536
  ds_read_b32 v133, v13 offset:1664
  ds_read_b32 v134, v13 offset:1792
  ds_read_b32 v135, v13 offset:1920
  ds_read_b32 v136, v13 offset:2048
  ds_read_b32 v137, v13 offset:2176
  ds_read_b32 v138, v13 offset:2304
  ds_read_b32 v139, v13 offset:2432
  v_mov_b32 v100, 0
  v_mov_b32 v101, 0
  v_mov_b32 v102, 0
  v_mov_b32 v103, 0
  v_mov_b32 v104, 0
  v_mov_b32 v105, 0
  v_mov_b32 v106, 0
  v_mov_b32 v107, 0
  s_waitcnt vmcnt(0) lgkmcnt(0)
  v_lshlrev_b32 v8, 16, v16
  v_and_b32 v9, s34, v16
  v_fmac_f32 v100, v8, v120
  v_fmac_f32 v101, v9, v120
  v_lshlrev_b32 v8, 16, v17
  v_and_b32 v9, s34, v17
  v_fmac_f32 v102, v8, v120
  v_fmac_f32 v103, v9, v120
  v_lshlrev_b32 v8, 16, v18
  v_and_b32 v9, s34, v18
  v_fmac_f32 v104, v8, v120
  v_fmac_f32 v105, v9, v120
  v_lshlrev_b32 v8, 16, v19
  v_and_b32 v9, s34, v19
  v_fmac_f32 v106, v8, v120
  v_fmac_f32 v107, v9, v120
  v_lshlrev_b32 v8, 16, v20
  v_and_b32 v9, s34, v20
  v_fmac_f32 v100, v8, v121
  v_fmac_f32 v101, v9, v121
  v_lshlrev_b32 v8, 16, v21
  v_and_b32 v9, s34, v21
  v_fmac_f32 v102, v8, v121
  v_fmac_f32 v103, v9, v121
  v_lshlrev_b32 v8, 16, v22
  v_and_b32 v9, s34, v22
  v_fmac_f32 v104, v8, v121
  v_fmac_f32 v105, v9, v121
  v_lshlrev_b32 v8, 16, v23
  v_and_b32 v9, s34, v23
  v_fmac_f32 v106, v8, v121
  v_fmac_f32 v107, v9, v121
  v_lshlrev_b32 v8, 16, v24
  v_and_b32 v9, s34, v24
  v_fmac_f32 v100, v8, v122
  v_fmac_f32 v101, v9, v122
  v_lshlrev_b32 v8, 16, v25
  v_and_b32 v9, s34, v25
  v_fmac_f32 v102, v8, v122
  v_fmac_f32 v103, v9, v122
  v_lshlrev_b32 v8, 16, v26
  v_and_b32 v9, s34, v26
  v_fmac_f32 v104, v8, v122
  v_fmac_f32 v105, v9, v122
  v_lshlrev_b32 v8, 16, v27
  v_and_b32 v9, s34, v27
  v_fmac_f32 v106, v8, v122
  v_fmac_f32 v107, v9, v122
  v_lshlrev_b32 v8, 16, v28
  v_and_b32 v9, s34, v28
  v_fmac_f32 v100, v8, v123
  v_fmac_f32 v101, v9, v123
  v_lshlrev_b32 v8, 16, v29
  v_and_b32 v9, s34, v29
  v_fmac_f32 v102, v8, v123
  v_fmac_f32 v103, v9, v123
  v_lshlrev_b32 v8, 16, v30
  v_and_b32 v9, s34, v30
  v_fmac_f32 v104, v8, v123
  v_fmac_f32 v105, v9, v123
  v_lshlrev_b32 v8, 16, v31
  v_and_b32 v9, s34, v31
  v_fmac_f32 v106, v8, v123
  v_fmac_f32 v107, v9, v123
  v_lshlrev_b32 v8, 16, v32
  v_and_b32 v9, s34, v32
  v_fmac_f32 v100, v8, v124
  v_fmac_f32 v101, v9, v124
  v_lshlrev_b32 v8, 16, v33
  v_and_b32 v9, s34, v33
  v_fmac_f32 v102, v8, v124
  v_fmac_f32 v103, v9, v124
  v_lshlrev_b32 v8, 16, v34
  v_and_b32 v9, s34, v34
  v_fmac_f32 v104, v8, v124
  v_fmac_f32 v105, v9, v124
  v_lshlrev_b32 v8, 16, v35
  v_and_b32 v9, s34, v35
  v_fmac_f32 v106, v8, v124
  v_fmac_f32 v107, v9, v124
  v_lshlrev_b32 v8, 16, v36
  v_and_b32 v9, s34, v36
  v_fmac_f32 v100, v8, v125
  v_fmac_f32 v101, v9, v125
  v_lshlrev_b32 v8, 16, v37
  v_and_b32 v9, s34, v37
  v_fmac_f32 v102, v8, v125
  v_fmac_f32 v103, v9, v125
  v_lshlrev_b32 v8, 16, v38
  v_and_b32 v9, s34, v38
  v_fmac_f32 v104, v8, v125
  v_fmac_f32 v105, v9, v125
  v_lshlrev_b32 v8, 16, v39
  v_and_b32 v9, s34, v39
  v_fmac_f32 v106, v8, v125
  v_fmac_f32 v107, v9, v125
  v_lshlrev_b32 v8, 16, v40
  v_and_b32 v9, s34, v40
  v_fmac_f32 v100, v8, v126
  v_fmac_f32 v101, v9, v126
  v_lshlrev_b32 v8, 16, v41
  v_and_b32 v9, s34, v41
  v_fmac_f32 v102, v8, v126
  v_fmac_f32 v103, v9, v126
  v_lshlrev_b32 v8, 16, v42
  v_and_b32 v9, s34, v42
  v_fmac_f32 v104, v8, v126
  v_fmac_f32 v105, v9, v126
  v_lshlrev_b32 v8, 16, v43
  v_and_b32 v9, s34, v43
  v_fmac_f32 v106, v8, v126
  v_fmac_f32 v107, v9, v126
  v_lshlrev_b32 v8, 16, v44
  v_and_b32 v9, s34, v44
  v_fmac_f32 v100, v8, v127
  v_fmac_f32 v101, v9, v127
  v_lshlrev_b32 v8, 16, v45
  v_and_b32 v9, s34, v45
  v_fmac_f32 v102, v8, v127
  v_fmac_f32 v103, v9, v127
  v_lshlrev_b32 v8, 16, v46
  v_and_b32 v9, s34, v46
  v_fmac_f32 v104, v8, v127
  v_fmac_f32 v105, v9, v127
  v_lshlrev_b32 v8, 16, v47
  v_and_b32 v9, s34, v47
  v_fmac_f32 v106, v8, v127
  v_fmac_f32 v107, v9, v127
  v_lshlrev_b32 v8, 16, v48
  v_and_b32 v9, s34, v48
  v_fmac_f32 v100, v8, v128
  v_fmac_f32 v101, v9, v128
  v_lshlrev_b32 v8, 16, v49
  v_and_b32 v9, s34, v49
  v_fmac_f32 v102, v8, v128
  v_fmac_f32 v103, v9, v128
  v_lshlrev_b32 v8, 16, v50
  v_and_b32 v9, s34, v50
  v_fmac_f32 v104, v8, v128
  v_fmac_f32 v105, v9, v128
  v_lshlrev_b32 v8, 16, v51
  v_and_b32 v9, s34, v51
  v_fmac_f32 v106, v8, v128
  v_fmac_f32 v107, v9, v128
  v_lshlrev_b32 v8, 16, v52
  v_and_b32 v9, s34, v52
  v_fmac_f32 v100, v8, v129
  v_fmac_f32 v101, v9, v129
  v_lshlrev_b32 v8, 16, v53
  v_and_b32 v9, s34, v53
  v_fmac_f32 v102, v8, v129
  v_fmac_f32 v103, v9, v129
  v_lshlrev_b32 v8, 16, v54
  v_and_b32 v9, s34, v54
  v_fmac_f32 v104, v8, v129
  v_fmac_f32 v105, v9, v129
  v_lshlrev_b32 v8, 16, v55
  v_and_b32 v9, s34, v55
  v_fmac_f32 v106, v8, v129
  v_fmac_f32 v107, v9, v129
  v_lshlrev_b32 v8, 16, v56
  v_and_b32 v9, s34, v56
  v_fmac_f32 v100, v8, v130
  v_fmac_f32 v101, v9, v130
  v_lshlrev_b32 v8, 16, v57
  v_and_b32 v9, s34, v57
  v_fmac_f32 v102, v8, v130
  v_fmac_f32 v103, v9, v130
  v_lshlrev_b32 v8, 16, v58
  v_and_b32 v9, s34, v58
  v_fmac_f32 v104, v8, v130
  v_fmac_f32 v105, v9, v130
  v_lshlrev_b32 v8, 16, v59
  v_and_b32 v9, s34, v59
  v_fmac_f32 v106, v8, v130
  v_fmac_f32 v107, v9, v130
  v_lshlrev_b32 v8, 16, v60
  v_and_b32 v9, s34, v60
  v_fmac_f32 v100, v8, v131
  v_fmac_f32 v101, v9, v131
  v_lshlrev_b32 v8, 16, v61
  v_and_b32 v9, s34, v61
  v_fmac_f32 v102, v8, v131
  v_fmac_f32 v103, v9, v131
  v_lshlrev_b32 v8, 16, v62
  v_and_b32 v9, s34, v62
  v_fmac_f32 v104, v8, v131
  v_fmac_f32 v105, v9, v131
  v_lshlrev_b32 v8, 16, v63
  v_and_b32 v9, s34, v63
  v_fmac_f32 v106, v8, v131
  v_fmac_f32 v107, v9, v131
  v_lshlrev_b32 v8, 16, v64
  v_and_b32 v9, s34, v64
  v_fmac_f32 v100, v8, v132
  v_fmac_f32 v101, v9, v132
  v_lshlrev_b32 v8, 16, v65
  v_and_b32 v9, s34, v65
  v_fmac_f32 v102, v8, v132
  v_fmac_f32 v103, v9, v132
  v_lshlrev_b32 v8, 16, v66
  v_and_b32 v9, s34, v66
  v_fmac_f32 v104, v8, v132
  v_fmac_f32 v105, v9, v132
  v_lshlrev_b32 v8, 16, v67
  v_and_b32 v9, s34, v67
  v_fmac_f32 v106, v8, v132
  v_fmac_f32 v107, v9, v132
  v_lshlrev_b32 v8, 16, v68
  v_and_b32 v9, s34, v68
  v_fmac_f32 v100, v8, v133
  v_fmac_f32 v101, v9, v133
  v_lshlrev_b32 v8, 16, v69
  v_and_b32 v9, s34, v69
  v_fmac_f32 v102, v8, v133
  v_fmac_f32 v103, v9, v133
  v_lshlrev_b32 v8, 16, v70
  v_and_b32 v9, s34, v70
  v_fmac_f32 v104, v8, v133
  v_fmac_f32 v105, v9, v133
  v_lshlrev_b32 v8, 16, v71
  v_and_b32 v9, s34, v71
  v_fmac_f32 v106, v8, v133
  v_fmac_f32 v107, v9, v133
  v_lshlrev_b32 v8, 16, v72
  v_and_b32 v9, s34, v72
  v_fmac_f32 v100, v8, v134
  v_fmac_f32 v101, v9, v134
  v_lshlrev_b32 v8, 16, v73
  v_and_b32 v9, s34, v73
  v_fmac_f32 v102, v8, v134
  v_fmac_f32 v103, v9, v134
  v_lshlrev_b32 v8, 16, v74
  v_and_b32 v9, s34, v74
  v_fmac_f32 v104, v8, v134
  v_fmac_f32 v105, v9, v134
  v_lshlrev_b32 v8, 16, v75
  v_and_b32 v9, s34, v75
  v_fmac_f32 v106, v8, v134
  v_fmac_f32 v107, v9, v134
  v_lshlrev_b32 v8, 16, v76
  v_and_b32 v9, s34, v76
  v_fmac_f32 v100, v8, v135
  v_fmac_f32 v101, v9, v135
  v_lshlrev_b32 v8, 16, v77
  v_and_b32 v9, s34, v77
  v_fmac_f32 v102, v8, v135
  v_fmac_f32 v103, v9, v135
  v_lshlrev_b32 v8, 16, v78
  v_and_b32 v9, s34, v78
  v_fmac_f32 v104, v8, v135
  v_fmac_f32 v105, v9, v135
  v_lshlrev_b32 v8, 16, v79
  v_and_b32 v9, s34, v79
  v_fmac_f32 v106, v8, v135
  v_fmac_f32 v107, v9, v135
  v_lshlrev_b32 v8, 16, v80
  v_and_b32 v9, s34, v80
  v_fmac_f32 v100, v8, v136
  v_fmac_f32 v101, v9, v136
  v_lshlrev_b32 v8, 16, v81
  v_and_b32 v9, s34, v81
  v_fmac_f32 v102, v8, v136
  v_fmac_f32 v103, v9, v136
  v_lshlrev_b32 v8, 16, v82
  v_and_b32 v9, s34, v82
  v_fmac_f32 v104, v8, v136
  v_fmac_f32 v105, v9, v136
  v_lshlrev_b32 v8, 16, v83
  v_and_b32 v9, s34, v83
  v_fmac_f32 v106, v8, v136
  v_fmac_f32 v107, v9, v136
  v_lshlrev_b32 v8, 16, v84
  v_and_b32 v9, s34, v84
  v_fmac_f32 v100, v8, v137
  v_fmac_f32 v101, v9, v137
  v_lshlrev_b32 v8, 16, v85
  v_and_b32 v9, s34, v85
  v_fmac_f32 v102, v8, v137
  v_fmac_f32 v103, v9, v137
  v_lshlrev_b32 v8, 16, v86
  v_and_b32 v9, s34, v86
  v_fmac_f32 v104, v8, v137
  v_fmac_f32 v105, v9, v137
  v_lshlrev_b32 v8, 16, v87
  v_and_b32 v9, s34, v87
  v_fmac_f32 v106, v8, v137
  v_fmac_f32 v107, v9, v137
  v_lshlrev_b32 v8, 16, v88
  v_and_b32 v9, s34, v88
  v_fmac_f32 v100, v8, v138
  v_fmac_f32 v101, v9, v138
  v_lshlrev_b32 v8, 16, v89
  v_and_b32 v9, s34, v89
  v_fmac_f32 v102, v8, v138
  v_fmac_f32 v103, v9, v138
  v_lshlrev_b32 v8, 16, v90
  v_and_b32 v9, s34, v90
  v_fmac_f32 v104, v8, v138
  v_fmac_f32 v105, v9, v138
  v_lshlrev_b32 v8, 16, v91
  v_and_b32 v9, s34, v91
  v_fmac_f32 v106, v8, v138
  v_fmac_f32 v107, v9, v138
  v_lshlrev_b32 v8, 16, v92
  v_and_b32 v9, s34, v92
  v_fmac_f32 v100, v8, v139
  v_fmac_f32 v101, v9, v139
  v_lshlrev_b32 v8, 16, v93
  v_and_b32 v9, s34, v93
  v_fmac_f32 v102, v8, v139
  v_fmac_f32 v103, v9, v139
  v_lshlrev_b32 v8, 16, v94
  v_and_b32 v9, s34, v94
  v_fmac_f32 v104, v8, v139
  v_fmac_f32 v105, v9, v139
  v_lshlrev_b32 v8, 16, v95
  v_and_b32 v9, s34, v95
  v_fmac_f32 v106, v8, v139
  v_fmac_f32 v107, v9, v139
  v_lshlrev_b32 v8, 8, v5
  v_lshl_add_u32 v8, v4, 5, v8
  ds_write_b128 v8, v[100:103] offset:10240
  ds_write_b128 v8, v[104:107] offset:10256
  s_waitcnt lgkmcnt(0)
  s_barrier
  v_cmp_gt_u32 vcc, 64, v0
  s_and_saveexec_b64 s[36:37], vcc
  s_cbranch_execz K1_END
  v_lshlrev_b32 v8, 2, v0
  ds_read_b32 v16, v8 offset:10240
  ds_read_b32 v17, v8 offset:10496
  ds_read_b32 v18, v8 offset:10752
  ds_read_b32 v19, v8 offset:11008
  ds_read_b32 v20, v8 offset:11264
  ds_read_b32 v21, v8 offset:11520
  ds_read_b32 v22, v8 offset:11776
  ds_read_b32 v23, v8 offset:12032
  ds_read_b32 v24, v8 offset:12288
  ds_read_b32 v25, v8 offset:12544
  ds_read_b32 v26, v8 offset:12800
  ds_read_b32 v27, v8 offset:13056
  ds_read_b32 v28, v8 offset:13312
  ds_read_b32 v29, v8 offset:13568
  ds_read_b32 v30, v8 offset:13824
  ds_read_b32 v31, v8 offset:14080
  ds_read_b32 v32, v8 offset:14336
  ds_read_b32 v33, v8 offset:14592
  ds_read_b32 v34, v8 offset:14848
  ds_read_b32 v35, v8 offset:15104
  ds_read_b32 v36, v8 offset:15360
  ds_read_b32 v37, v8 offset:15616
  ds_read_b32 v38, v8 offset:15872
  ds_read_b32 v39, v8 offset:16128
  ds_read_b32 v40, v8 offset:16384
  ds_read_b32 v41, v8 offset:16640
  ds_read_b32 v42, v8 offset:16896
  ds_read_b32 v43, v8 offset:17152
  ds_read_b32 v44, v8 offset:17408
  ds_read_b32 v45, v8 offset:17664
  ds_read_b32 v46, v8 offset:17920
  ds_read_b32 v47, v8 offset:18176
  s_waitcnt lgkmcnt(0)
  v_add_f32 v16, v16, v17
  v_add_f32 v16, v16, v18
  v_add_f32 v16, v16, v19
  v_add_f32 v16, v16, v20
  v_add_f32 v16, v16, v21
  v_add_f32 v16, v16, v22
  v_add_f32 v16, v16, v23
  v_add_f32 v16, v16, v24
  v_add_f32 v16, v16, v25
  v_add_f32 v16, v16, v26
  v_add_f32 v16, v16, v27
  v_add_f32 v16, v16, v28
  v_add_f32 v16, v16, v29
  v_add_f32 v16, v16, v30
  v_add_f32 v16, v16, v31
  v_add_f32 v16, v16, v32
  v_add_f32 v16, v16, v33
  v_add_f32 v16, v16, v34
  v_add_f32 v16, v16, v35
  v_add_f32 v16, v16, v36
  v_add_f32 v16, v16, v37
  v_add_f32 v16, v16, v38
  v_add_f32 v16, v16, v39
  v_add_f32 v16, v16, v40
  v_add_f32 v16, v16, v41
  v_add_f32 v16, v16, v42
  v_add_f32 v16, v16, v43
  v_add_f32 v16, v16, v44
  v_add_f32 v16, v16, v45
  v_add_f32 v16, v16, v46
  v_add_f32 v16, v16, v47
  v_cvt_pk_bf16_f32 v16, v16, v16
  s_lshl_b32 s22, s22, 1
  v_lshl_add_u32 v8, v0, 1, s22
  buffer_store_short v16, v8, s[28:31], 0 offen offset:0
K1_END:
  s_endpgm
.globl attn_kernel
.p2align 8
.type attn_kernel,@function
attn_kernel:
  s_cmp_ge_u32 s2, 512
  s_cbranch_scc1 K2_END
  s_load_dwordx4 s[24:27], s[0:1], 8
  s_load_dwordx2 s[28:29], s[0:1], 88
  v_and_b32 v1, 63, v0
  v_lshrrev_b32 v2, 6, v0
  s_nop 0
  v_readfirstlane_b32 s20, v2
  s_waitcnt lgkmcnt(0)
  s_mov_b32 s4, s24
  s_and_b32 s5, s25, 0xffff
  s_mov_b32 s6, 402653184
  s_mov_b32 s7, 0x00020000
  s_mov_b32 s8, s26
  s_and_b32 s9, s27, 0xffff
  s_mov_b32 s10, 402653184
  s_mov_b32 s11, 0x00020000
  s_mov_b32 s12, s28
  s_and_b32 s13, s29, 0xffff
  s_mov_b32 s14, 1610612736
  s_mov_b32 s15, 0x00020000
  s_lshr_b32 s18, s2, 4
  s_and_b32 s19, s2, 15
  s_mul_i32 s16, s18, 12582912
  s_mul_i32 s17, s19, 786432
  s_add_u32 s16, s16, s17
  s_mul_i32 s17, s20, 196608
  s_add_u32 s16, s16, s17
  s_mov_b32 s21, 0x3fb8aa3b
  s_mov_b32 s22, 0x3d93cd3a
  s_mov_b32 s23, 0xbfb8aa3b
  s_mov_b32 s30, 0xffff0000
  v_lshrrev_b32 v3, 3, v1
  v_and_b32 v4, 7, v1
  v_mul_u32_u24 v1, 384, v3
  v_lshl_add_u32 v1, v4, 4, v1
  s_mul_i32 s17, s18, 384
  v_lshl_add_u32 v5, v4, 4, s17
  buffer_load_dwordx4 v[6:9], v5, s[12:15], 0 offen offset:0
  buffer_load_dwordx4 v[10:13], v5, s[12:15], 0 offen offset:128
  buffer_load_dwordx4 v[14:17], v5, s[12:15], 0 offen offset:256
  v_mov_b32 v18, 0xff800000
  v_mov_b32 v19, 0
  v_mov_b32 v20, 0
  v_mov_b32 v21, 0
  v_mov_b32 v22, 0
  v_mov_b32 v23, 0
  v_mov_b32 v24, 0
  v_mov_b32 v25, 0
  v_mov_b32 v26, 0
  v_mov_b32 v27, 0
  v_mov_b32 v28, 0
  v_mov_b32 v29, 0
  v_mov_b32 v30, 0
  v_mov_b32 v31, 0
  v_mov_b32 v32, 0
  v_mov_b32 v33, 0
  v_mov_b32 v34, 0
  v_mov_b32 v35, 0
  v_mov_b32 v36, 0
  v_mov_b32 v37, 0
  v_mov_b32 v38, 0
  v_mov_b32 v39, 0
  v_mov_b32 v40, 0
  v_mov_b32 v41, 0
  v_mov_b32 v42, 0
  v_mov_b32 v43, 0
  buffer_load_dwordx4 v[44:47], v1, s[4:7], s16 offen offset:0 nt
  buffer_load_dwordx4 v[48:51], v1, s[4:7], s16 offen offset:128 nt
  buffer_load_dwordx4 v[52:55], v1, s[4:7], s16 offen offset:256 nt
  buffer_load_dwordx4 v[56:59], v1, s[4:7], s16 offen offset:3072 nt
  buffer_load_dwordx4 v[60:63], v1, s[4:7], s16 offen offset:3200 nt
  buffer_load_dwordx4 v[64:67], v1, s[4:7], s16 offen offset:3328 nt
  buffer_load_dwordx4 v[68:71], v1, s[8:11], s16 offen offset:0 nt
  buffer_load_dwordx4 v[72:75], v1, s[8:11], s16 offen offset:128 nt
  buffer_load_dwordx4 v[76:79], v1, s[8:11], s16 offen offset:256 nt
  buffer_load_dwordx4 v[80:83], v1, s[8:11], s16 offen offset:3072 nt
  buffer_load_dwordx4 v[84:87], v1, s[8:11], s16 offen offset:3200 nt
  buffer_load_dwordx4 v[88:91], v1, s[8:11], s16 offen offset:3328 nt
  s_add_u32 s16, s16, 6144
  s_mov_b32 s17, 15
K2_LOOP:
  buffer_load_dwordx4 v[92:95], v1, s[4:7], s16 offen offset:0 nt
  buffer_load_dwordx4 v[96:99], v1, s[4:7], s16 offen offset:128 nt
  buffer_load_dwordx4 v[100:103], v1, s[4:7], s16 offen offset:256 nt
  buffer_load_dwordx4 v[104:107], v1, s[4:7], s16 offen offset:3072 nt
  buffer_load_dwordx4 v[108:111], v1, s[4:7], s16 offen offset:3200 nt
  buffer_load_dwordx4 v[112:115], v1, s[4:7], s16 offen offset:3328 nt
  buffer_load_dwordx4 v[116:119], v1, s[8:11], s16 offen offset:0 nt
  buffer_load_dwordx4 v[120:123], v1, s[8:11], s16 offen offset:128 nt
  buffer_load_dwordx4 v[124:127], v1, s[8:11], s16 offen offset:256 nt
  buffer_load_dwordx4 v[128:131], v1, s[8:11], s16 offen offset:3072 nt
  buffer_load_dwordx4 v[132:135], v1, s[8:11], s16 offen offset:3200 nt
  buffer_load_dwordx4 v[136:139], v1, s[8:11], s16 offen offset:3328 nt
  s_add_u32 s16, s16, 6144
  s_waitcnt vmcnt(18)
  v_dot2_f32_bf16 v140, v44, v6, 0
  v_dot2c_f32_bf16 v140, v45, v7
  v_dot2c_f32_bf16 v140, v46, v8
  v_dot2c_f32_bf16 v140, v47, v9
  v_dot2_f32_bf16 v141, v48, v10, 0
  v_dot2c_f32_bf16 v141, v49, v11
  v_dot2c_f32_bf16 v141, v50, v12
  v_dot2c_f32_bf16 v141, v51, v13
  v_dot2_f32_bf16 v142, v52, v14, 0
  v_dot2c_f32_bf16 v142, v53, v15
  v_dot2c_f32_bf16 v142, v54, v16
  v_dot2c_f32_bf16 v142, v55, v17
  v_dot2_f32_bf16 v143, v56, v6, 0
  v_dot2c_f32_bf16 v143, v57, v7
  v_dot2c_f32_bf16 v143, v58, v8
  v_dot2c_f32_bf16 v143, v59, v9
  v_dot2_f32_bf16 v144, v60, v10, 0
  v_dot2c_f32_bf16 v144, v61, v11
  v_dot2c_f32_bf16 v144, v62, v12
  v_dot2c_f32_bf16 v144, v63, v13
  v_dot2_f32_bf16 v145, v64, v14, 0
  v_dot2c_f32_bf16 v145, v65, v15
  v_dot2c_f32_bf16 v145, v66, v16
  v_dot2c_f32_bf16 v145, v67, v17
  v_add_f32 v140, v140, v141
  v_add_f32 v143, v143, v144
  v_add_f32 v140, v140, v142
  v_add_f32 v143, v143, v145
  s_nop 0
  v_add_f32_dpp v140, v140, v140 quad_perm:[1,0,3,2] row_mask:0xf bank_mask:0xf
  v_add_f32_dpp v143, v143, v143 quad_perm:[1,0,3,2] row_mask:0xf bank_mask:0xf
  s_nop 0
  v_add_f32_dpp v140, v140, v140 quad_perm:[2,3,0,1] row_mask:0xf bank_mask:0xf
  v_add_f32_dpp v143, v143, v143 quad_perm:[2,3,0,1] row_mask:0xf bank_mask:0xf
  s_nop 0
  v_add_f32_dpp v140, v140, v140 row_half_mirror row_mask:0xf bank_mask:0xf
  v_add_f32_dpp v143, v143, v143 row_half_mirror row_mask:0xf bank_mask:0xf
  v_cvt_pk_bf16_f32 v141, v140, v143
  v_lshlrev_b32 v140, 16, v141
  v_and_b32 v143, s30, v141
  v_mul_f32 v140, s22, v140
  v_mul_f32 v143, s22, v143
  v_cvt_pk_bf16_f32 v141, v140, v143
  v_lshlrev_b32 v140, 16, v141
  v_and_b32 v143, s30, v141
  v_max3_f32 v146, v18, v140, v143
  v_mul_f32 v147, s23, v146
  v_fma_f32 v148, v18, s21, v147
  v_fma_f32 v140, v140, s21, v147
  v_fma_f32 v143, v143, s21, v147
  v_exp_f32 v148, v148
  v_exp_f32 v140, v140
  v_exp_f32 v143, v143
  v_mov_b32 v18, v146
  v_fma_f32 v19, v19, v148, v140
  v_add_f32 v19, v19, v143
  s_waitcnt vmcnt(12)
  v_lshlrev_b32 v150, 16, v68
  v_and_b32 v151, s30, v68
  v_lshlrev_b32 v152, 16, v80
  v_and_b32 v153, s30, v80
  v_mul_f32 v20, v20, v148
  v_mul_f32 v21, v21, v148
  v_fmac_f32 v20, v140, v150
  v_fmac_f32 v21, v140, v151
  v_fmac_f32 v20, v143, v152
  v_fmac_f32 v21, v143, v153
  v_lshlrev_b32 v150, 16, v69
  v_and_b32 v151, s30, v69
  v_lshlrev_b32 v152, 16, v81
  v_and_b32 v153, s30, v81
  v_mul_f32 v22, v22, v148
  v_mul_f32 v23, v23, v148
  v_fmac_f32 v22, v140, v150
  v_fmac_f32 v23, v140, v151
  v_fmac_f32 v22, v143, v152
  v_fmac_f32 v23, v143, v153
  v_lshlrev_b32 v150, 16, v70
  v_and_b32 v151, s30, v70
  v_lshlrev_b32 v152, 16, v82
  v_and_b32 v153, s30, v82
  v_mul_f32 v24, v24, v148
  v_mul_f32 v25, v25, v148
  v_fmac_f32 v24, v140, v150
  v_fmac_f32 v25, v140, v151
  v_fmac_f32 v24, v143, v152
  v_fmac_f32 v25, v143, v153
  v_lshlrev_b32 v150, 16, v71
  v_and_b32 v151, s30, v71
  v_lshlrev_b32 v152, 16, v83
  v_and_b32 v153, s30, v83
  v_mul_f32 v26, v26, v148
  v_mul_f32 v27, v27, v148
  v_fmac_f32 v26, v140, v150
  v_fmac_f32 v27, v140, v151
  v_fmac_f32 v26, v143, v152
  v_fmac_f32 v27, v143, v153
  v_lshlrev_b32 v150, 16, v72
  v_and_b32 v151, s30, v72
  v_lshlrev_b32 v152, 16, v84
  v_and_b32 v153, s30, v84
  v_mul_f32 v28, v28, v148
  v_mul_f32 v29, v29, v148
  v_fmac_f32 v28, v140, v150
  v_fmac_f32 v29, v140, v151
  v_fmac_f32 v28, v143, v152
  v_fmac_f32 v29, v143, v153
  v_lshlrev_b32 v150, 16, v73
  v_and_b32 v151, s30, v73
  v_lshlrev_b32 v152, 16, v85
  v_and_b32 v153, s30, v85
  v_mul_f32 v30, v30, v148
  v_mul_f32 v31, v31, v148
  v_fmac_f32 v30, v140, v150
  v_fmac_f32 v31, v140, v151
  v_fmac_f32 v30, v143, v152
  v_fmac_f32 v31, v143, v153
  v_lshlrev_b32 v150, 16, v74
  v_and_b32 v151, s30, v74
  v_lshlrev_b32 v152, 16, v86
  v_and_b32 v153, s30, v86
  v_mul_f32 v32, v32, v148
  v_mul_f32 v33, v33, v148
  v_fmac_f32 v32, v140, v150
  v_fmac_f32 v33, v140, v151
  v_fmac_f32 v32, v143, v152
  v_fmac_f32 v33, v143, v153
  v_lshlrev_b32 v150, 16, v75
  v_and_b32 v151, s30, v75
  v_lshlrev_b32 v152, 16, v87
  v_and_b32 v153, s30, v87
  v_mul_f32 v34, v34, v148
  v_mul_f32 v35, v35, v148
  v_fmac_f32 v34, v140, v150
  v_fmac_f32 v35, v140, v151
  v_fmac_f32 v34, v143, v152
  v_fmac_f32 v35, v143, v153
  v_lshlrev_b32 v150, 16, v76
  v_and_b32 v151, s30, v76
  v_lshlrev_b32 v152, 16, v88
  v_and_b32 v153, s30, v88
  v_mul_f32 v36, v36, v148
  v_mul_f32 v37, v37, v148
  v_fmac_f32 v36, v140, v150
  v_fmac_f32 v37, v140, v151
  v_fmac_f32 v36, v143, v152
  v_fmac_f32 v37, v143, v153
  v_lshlrev_b32 v150, 16, v77
  v_and_b32 v151, s30, v77
  v_lshlrev_b32 v152, 16, v89
  v_and_b32 v153, s30, v89
  v_mul_f32 v38, v38, v148
  v_mul_f32 v39, v39, v148
  v_fmac_f32 v38, v140, v150
  v_fmac_f32 v39, v140, v151
  v_fmac_f32 v38, v143, v152
  v_fmac_f32 v39, v143, v153
  v_lshlrev_b32 v150, 16, v78
  v_and_b32 v151, s30, v78
  v_lshlrev_b32 v152, 16, v90
  v_and_b32 v153, s30, v90
  v_mul_f32 v40, v40, v148
  v_mul_f32 v41, v41, v148
  v_fmac_f32 v40, v140, v150
  v_fmac_f32 v41, v140, v151
  v_fmac_f32 v40, v143, v152
  v_fmac_f32 v41, v143, v153
  v_lshlrev_b32 v150, 16, v79
  v_and_b32 v151, s30, v79
  v_lshlrev_b32 v152, 16, v91
  v_and_b32 v153, s30, v91
  v_mul_f32 v42, v42, v148
  v_mul_f32 v43, v43, v148
  v_fmac_f32 v42, v140, v150
  v_fmac_f32 v43, v140, v151
  v_fmac_f32 v42, v143, v152
  v_fmac_f32 v43, v143, v153
  buffer_load_dwordx4 v[44:47], v1, s[4:7], s16 offen offset:0 nt
  buffer_load_dwordx4 v[48:51], v1, s[4:7], s16 offen offset:128 nt
  buffer_load_dwordx4 v[52:55], v1, s[4:7], s16 offen offset:256 nt
  buffer_load_dwordx4 v[56:59], v1, s[4:7], s16 offen offset:3072 nt
  buffer_load_dwordx4 v[60:63], v1, s[4:7], s16 offen offset:3200 nt
  buffer_load_dwordx4 v[64:67], v1, s[4:7], s16 offen offset:3328 nt
  buffer_load_dwordx4 v[68:71], v1, s[8:11], s16 offen offset:0 nt
  buffer_load_dwordx4 v[72:75], v1, s[8:11], s16 offen offset:128 nt
  buffer_load_dwordx4 v[76:79], v1, s[8:11], s16 offen offset:256 nt
  buffer_load_dwordx4 v[80:83], v1, s[8:11], s16 offen offset:3072 nt
  buffer_load_dwordx4 v[84:87], v1, s[8:11], s16 offen offset:3200 nt
  buffer_load_dwordx4 v[88:91], v1, s[8:11], s16 offen offset:3328 nt
  s_add_u32 s16, s16, 6144
  s_waitcnt vmcnt(18)
  v_dot2_f32_bf16 v140, v92, v6, 0
  v_dot2c_f32_bf16 v140, v93, v7
  v_dot2c_f32_bf16 v140, v94, v8
  v_dot2c_f32_bf16 v140, v95, v9
  v_dot2_f32_bf16 v141, v96, v10, 0
  v_dot2c_f32_bf16 v141, v97, v11
  v_dot2c_f32_bf16 v141, v98, v12
  v_dot2c_f32_bf16 v141, v99, v13
  v_dot2_f32_bf16 v142, v100, v14, 0
  v_dot2c_f32_bf16 v142, v101, v15
  v_dot2c_f32_bf16 v142, v102, v16
  v_dot2c_f32_bf16 v142, v103, v17
  v_dot2_f32_bf16 v143, v104, v6, 0
  v_dot2c_f32_bf16 v143, v105, v7
  v_dot2c_f32_bf16 v143, v106, v8
  v_dot2c_f32_bf16 v143, v107, v9
  v_dot2_f32_bf16 v144, v108, v10, 0
  v_dot2c_f32_bf16 v144, v109, v11
  v_dot2c_f32_bf16 v144, v110, v12
  v_dot2c_f32_bf16 v144, v111, v13
  v_dot2_f32_bf16 v145, v112, v14, 0
  v_dot2c_f32_bf16 v145, v113, v15
  v_dot2c_f32_bf16 v145, v114, v16
  v_dot2c_f32_bf16 v145, v115, v17
  v_add_f32 v140, v140, v141
  v_add_f32 v143, v143, v144
  v_add_f32 v140, v140, v142
  v_add_f32 v143, v143, v145
  s_nop 0
  v_add_f32_dpp v140, v140, v140 quad_perm:[1,0,3,2] row_mask:0xf bank_mask:0xf
  v_add_f32_dpp v143, v143, v143 quad_perm:[1,0,3,2] row_mask:0xf bank_mask:0xf
  s_nop 0
  v_add_f32_dpp v140, v140, v140 quad_perm:[2,3,0,1] row_mask:0xf bank_mask:0xf
  v_add_f32_dpp v143, v143, v143 quad_perm:[2,3,0,1] row_mask:0xf bank_mask:0xf
  s_nop 0
  v_add_f32_dpp v140, v140, v140 row_half_mirror row_mask:0xf bank_mask:0xf
  v_add_f32_dpp v143, v143, v143 row_half_mirror row_mask:0xf bank_mask:0xf
  v_cvt_pk_bf16_f32 v141, v140, v143
  v_lshlrev_b32 v140, 16, v141
  v_and_b32 v143, s30, v141
  v_mul_f32 v140, s22, v140
  v_mul_f32 v143, s22, v143
  v_cvt_pk_bf16_f32 v141, v140, v143
  v_lshlrev_b32 v140, 16, v141
  v_and_b32 v143, s30, v141
  v_max3_f32 v146, v18, v140, v143
  v_mul_f32 v147, s23, v146
  v_fma_f32 v148, v18, s21, v147
  v_fma_f32 v140, v140, s21, v147
  v_fma_f32 v143, v143, s21, v147
  v_exp_f32 v148, v148
  v_exp_f32 v140, v140
  v_exp_f32 v143, v143
  v_mov_b32 v18, v146
  v_fma_f32 v19, v19, v148, v140
  v_add_f32 v19, v19, v143
  s_waitcnt vmcnt(12)
  v_lshlrev_b32 v150, 16, v116
  v_and_b32 v151, s30, v116
  v_lshlrev_b32 v152, 16, v128
  v_and_b32 v153, s30, v128
  v_mul_f32 v20, v20, v148
  v_mul_f32 v21, v21, v148
  v_fmac_f32 v20, v140, v150
  v_fmac_f32 v21, v140, v151
  v_fmac_f32 v20, v143, v152
  v_fmac_f32 v21, v143, v153
  v_lshlrev_b32 v150, 16, v117
  v_and_b32 v151, s30, v117
  v_lshlrev_b32 v152, 16, v129
  v_and_b32 v153, s30, v129
  v_mul_f32 v22, v22, v148
  v_mul_f32 v23, v23, v148
  v_fmac_f32 v22, v140, v150
  v_fmac_f32 v23, v140, v151
  v_fmac_f32 v22, v143, v152
  v_fmac_f32 v23, v143, v153
  v_lshlrev_b32 v150, 16, v118
  v_and_b32 v151, s30, v118
  v_lshlrev_b32 v152, 16, v130
  v_and_b32 v153, s30, v130
  v_mul_f32 v24, v24, v148
  v_mul_f32 v25, v25, v148
  v_fmac_f32 v24, v140, v150
  v_fmac_f32 v25, v140, v151
  v_fmac_f32 v24, v143, v152
  v_fmac_f32 v25, v143, v153
  v_lshlrev_b32 v150, 16, v119
  v_and_b32 v151, s30, v119
  v_lshlrev_b32 v152, 16, v131
  v_and_b32 v153, s30, v131
  v_mul_f32 v26, v26, v148
  v_mul_f32 v27, v27, v148
  v_fmac_f32 v26, v140, v150
  v_fmac_f32 v27, v140, v151
  v_fmac_f32 v26, v143, v152
  v_fmac_f32 v27, v143, v153
  v_lshlrev_b32 v150, 16, v120
  v_and_b32 v151, s30, v120
  v_lshlrev_b32 v152, 16, v132
  v_and_b32 v153, s30, v132
  v_mul_f32 v28, v28, v148
  v_mul_f32 v29, v29, v148
  v_fmac_f32 v28, v140, v150
  v_fmac_f32 v29, v140, v151
  v_fmac_f32 v28, v143, v152
  v_fmac_f32 v29, v143, v153
  v_lshlrev_b32 v150, 16, v121
  v_and_b32 v151, s30, v121
  v_lshlrev_b32 v152, 16, v133
  v_and_b32 v153, s30, v133
  v_mul_f32 v30, v30, v148
  v_mul_f32 v31, v31, v148
  v_fmac_f32 v30, v140, v150
  v_fmac_f32 v31, v140, v151
  v_fmac_f32 v30, v143, v152
  v_fmac_f32 v31, v143, v153
  v_lshlrev_b32 v150, 16, v122
  v_and_b32 v151, s30, v122
  v_lshlrev_b32 v152, 16, v134
  v_and_b32 v153, s30, v134
  v_mul_f32 v32, v32, v148
  v_mul_f32 v33, v33, v148
  v_fmac_f32 v32, v140, v150
  v_fmac_f32 v33, v140, v151
  v_fmac_f32 v32, v143, v152
  v_fmac_f32 v33, v143, v153
  v_lshlrev_b32 v150, 16, v123
  v_and_b32 v151, s30, v123
  v_lshlrev_b32 v152, 16, v135
  v_and_b32 v153, s30, v135
  v_mul_f32 v34, v34, v148
  v_mul_f32 v35, v35, v148
  v_fmac_f32 v34, v140, v150
  v_fmac_f32 v35, v140, v151
  v_fmac_f32 v34, v143, v152
  v_fmac_f32 v35, v143, v153
  v_lshlrev_b32 v150, 16, v124
  v_and_b32 v151, s30, v124
  v_lshlrev_b32 v152, 16, v136
  v_and_b32 v153, s30, v136
  v_mul_f32 v36, v36, v148
  v_mul_f32 v37, v37, v148
  v_fmac_f32 v36, v140, v150
  v_fmac_f32 v37, v140, v151
  v_fmac_f32 v36, v143, v152
  v_fmac_f32 v37, v143, v153
  v_lshlrev_b32 v150, 16, v125
  v_and_b32 v151, s30, v125
  v_lshlrev_b32 v152, 16, v137
  v_and_b32 v153, s30, v137
  v_mul_f32 v38, v38, v148
  v_mul_f32 v39, v39, v148
  v_fmac_f32 v38, v140, v150
  v_fmac_f32 v39, v140, v151
  v_fmac_f32 v38, v143, v152
  v_fmac_f32 v39, v143, v153
  v_lshlrev_b32 v150, 16, v126
  v_and_b32 v151, s30, v126
  v_lshlrev_b32 v152, 16, v138
  v_and_b32 v153, s30, v138
  v_mul_f32 v40, v40, v148
  v_mul_f32 v41, v41, v148
  v_fmac_f32 v40, v140, v150
  v_fmac_f32 v41, v140, v151
  v_fmac_f32 v40, v143, v152
  v_fmac_f32 v41, v143, v153
  v_lshlrev_b32 v150, 16, v127
  v_and_b32 v151, s30, v127
  v_lshlrev_b32 v152, 16, v139
  v_and_b32 v153, s30, v139
  v_mul_f32 v42, v42, v148
  v_mul_f32 v43, v43, v148
  v_fmac_f32 v42, v140, v150
  v_fmac_f32 v43, v140, v151
  v_fmac_f32 v42, v143, v152
  v_fmac_f32 v43, v143, v153
  s_sub_u32 s17, s17, 1
  s_cmp_lg_u32 s17, 0
  s_cbranch_scc1 K2_LOOP
  buffer_load_dwordx4 v[92:95], v1, s[4:7], s16 offen offset:0 nt
  buffer_load_dwordx4 v[96:99], v1, s[4:7], s16 offen offset:128 nt
  buffer_load_dwordx4 v[100:103], v1, s[4:7], s16 offen offset:256 nt
  buffer_load_dwordx4 v[104:107], v1, s[4:7], s16 offen offset:3072 nt
  buffer_load_dwordx4 v[108:111], v1, s[4:7], s16 offen offset:3200 nt
  buffer_load_dwordx4 v[112:115], v1, s[4:7], s16 offen offset:3328 nt
  buffer_load_dwordx4 v[116:119], v1, s[8:11], s16 offen offset:0 nt
  buffer_load_dwordx4 v[120:123], v1, s[8:11], s16 offen offset:128 nt
  buffer_load_dwordx4 v[124:127], v1, s[8:11], s16 offen offset:256 nt
  buffer_load_dwordx4 v[128:131], v1, s[8:11], s16 offen offset:3072 nt
  buffer_load_dwordx4 v[132:135], v1, s[8:11], s16 offen offset:3200 nt
  buffer_load_dwordx4 v[136:139], v1, s[8:11], s16 offen offset:3328 nt
  s_add_u32 s16, s16, 6144
  s_waitcnt vmcnt(18)
  v_dot2_f32_bf16 v140, v44, v6, 0
  v_dot2c_f32_bf16 v140, v45, v7
  v_dot2c_f32_bf16 v140, v46, v8
  v_dot2c_f32_bf16 v140, v47, v9
  v_dot2_f32_bf16 v141, v48, v10, 0
  v_dot2c_f32_bf16 v141, v49, v11
  v_dot2c_f32_bf16 v141, v50, v12
  v_dot2c_f32_bf16 v141, v51, v13
  v_dot2_f32_bf16 v142, v52, v14, 0
  v_dot2c_f32_bf16 v142, v53, v15
  v_dot2c_f32_bf16 v142, v54, v16
  v_dot2c_f32_bf16 v142, v55, v17
  v_dot2_f32_bf16 v143, v56, v6, 0
  v_dot2c_f32_bf16 v143, v57, v7
  v_dot2c_f32_bf16 v143, v58, v8
  v_dot2c_f32_bf16 v143, v59, v9
  v_dot2_f32_bf16 v144, v60, v10, 0
  v_dot2c_f32_bf16 v144, v61, v11
  v_dot2c_f32_bf16 v144, v62, v12
  v_dot2c_f32_bf16 v144, v63, v13
  v_dot2_f32_bf16 v145, v64, v14, 0
  v_dot2c_f32_bf16 v145, v65, v15
  v_dot2c_f32_bf16 v145, v66, v16
  v_dot2c_f32_bf16 v145, v67, v17
  v_add_f32 v140, v140, v141
  v_add_f32 v143, v143, v144
  v_add_f32 v140, v140, v142
  v_add_f32 v143, v143, v145
  s_nop 0
  v_add_f32_dpp v140, v140, v140 quad_perm:[1,0,3,2] row_mask:0xf bank_mask:0xf
  v_add_f32_dpp v143, v143, v143 quad_perm:[1,0,3,2] row_mask:0xf bank_mask:0xf
  s_nop 0
  v_add_f32_dpp v140, v140, v140 quad_perm:[2,3,0,1] row_mask:0xf bank_mask:0xf
  v_add_f32_dpp v143, v143, v143 quad_perm:[2,3,0,1] row_mask:0xf bank_mask:0xf
  s_nop 0
  v_add_f32_dpp v140, v140, v140 row_half_mirror row_mask:0xf bank_mask:0xf
  v_add_f32_dpp v143, v143, v143 row_half_mirror row_mask:0xf bank_mask:0xf
  v_cvt_pk_bf16_f32 v141, v140, v143
  v_lshlrev_b32 v140, 16, v141
  v_and_b32 v143, s30, v141
  v_mul_f32 v140, s22, v140
  v_mul_f32 v143, s22, v143
  v_cvt_pk_bf16_f32 v141, v140, v143
  v_lshlrev_b32 v140, 16, v141
  v_and_b32 v143, s30, v141
  v_max3_f32 v146, v18, v140, v143
  v_mul_f32 v147, s23, v146
  v_fma_f32 v148, v18, s21, v147
  v_fma_f32 v140, v140, s21, v147
  v_fma_f32 v143, v143, s21, v147
  v_exp_f32 v148, v148
  v_exp_f32 v140, v140
  v_exp_f32 v143, v143
  v_mov_b32 v18, v146
  v_fma_f32 v19, v19, v148, v140
  v_add_f32 v19, v19, v143
  s_waitcnt vmcnt(12)
  v_lshlrev_b32 v150, 16, v68
  v_and_b32 v151, s30, v68
  v_lshlrev_b32 v152, 16, v80
  v_and_b32 v153, s30, v80
  v_mul_f32 v20, v20, v148
  v_mul_f32 v21, v21, v148
  v_fmac_f32 v20, v140, v150
  v_fmac_f32 v21, v140, v151
  v_fmac_f32 v20, v143, v152
  v_fmac_f32 v21, v143, v153
  v_lshlrev_b32 v150, 16, v69
  v_and_b32 v151, s30, v69
  v_lshlrev_b32 v152, 16, v81
  v_and_b32 v153, s30, v81
  v_mul_f32 v22, v22, v148
  v_mul_f32 v23, v23, v148
  v_fmac_f32 v22, v140, v150
  v_fmac_f32 v23, v140, v151
  v_fmac_f32 v22, v143, v152
  v_fmac_f32 v23, v143, v153
  v_lshlrev_b32 v150, 16, v70
  v_and_b32 v151, s30, v70
  v_lshlrev_b32 v152, 16, v82
  v_and_b32 v153, s30, v82
  v_mul_f32 v24, v24, v148
  v_mul_f32 v25, v25, v148
  v_fmac_f32 v24, v140, v150
  v_fmac_f32 v25, v140, v151
  v_fmac_f32 v24, v143, v152
  v_fmac_f32 v25, v143, v153
  v_lshlrev_b32 v150, 16, v71
  v_and_b32 v151, s30, v71
  v_lshlrev_b32 v152, 16, v83
  v_and_b32 v153, s30, v83
  v_mul_f32 v26, v26, v148
  v_mul_f32 v27, v27, v148
  v_fmac_f32 v26, v140, v150
  v_fmac_f32 v27, v140, v151
  v_fmac_f32 v26, v143, v152
  v_fmac_f32 v27, v143, v153
  v_lshlrev_b32 v150, 16, v72
  v_and_b32 v151, s30, v72
  v_lshlrev_b32 v152, 16, v84
  v_and_b32 v153, s30, v84
  v_mul_f32 v28, v28, v148
  v_mul_f32 v29, v29, v148
  v_fmac_f32 v28, v140, v150
  v_fmac_f32 v29, v140, v151
  v_fmac_f32 v28, v143, v152
  v_fmac_f32 v29, v143, v153
  v_lshlrev_b32 v150, 16, v73
  v_and_b32 v151, s30, v73
  v_lshlrev_b32 v152, 16, v85
  v_and_b32 v153, s30, v85
  v_mul_f32 v30, v30, v148
  v_mul_f32 v31, v31, v148
  v_fmac_f32 v30, v140, v150
  v_fmac_f32 v31, v140, v151
  v_fmac_f32 v30, v143, v152
  v_fmac_f32 v31, v143, v153
  v_lshlrev_b32 v150, 16, v74
  v_and_b32 v151, s30, v74
  v_lshlrev_b32 v152, 16, v86
  v_and_b32 v153, s30, v86
  v_mul_f32 v32, v32, v148
  v_mul_f32 v33, v33, v148
  v_fmac_f32 v32, v140, v150
  v_fmac_f32 v33, v140, v151
  v_fmac_f32 v32, v143, v152
  v_fmac_f32 v33, v143, v153
  v_lshlrev_b32 v150, 16, v75
  v_and_b32 v151, s30, v75
  v_lshlrev_b32 v152, 16, v87
  v_and_b32 v153, s30, v87
  v_mul_f32 v34, v34, v148
  v_mul_f32 v35, v35, v148
  v_fmac_f32 v34, v140, v150
  v_fmac_f32 v35, v140, v151
  v_fmac_f32 v34, v143, v152
  v_fmac_f32 v35, v143, v153
  v_lshlrev_b32 v150, 16, v76
  v_and_b32 v151, s30, v76
  v_lshlrev_b32 v152, 16, v88
  v_and_b32 v153, s30, v88
  v_mul_f32 v36, v36, v148
  v_mul_f32 v37, v37, v148
  v_fmac_f32 v36, v140, v150
  v_fmac_f32 v37, v140, v151
  v_fmac_f32 v36, v143, v152
  v_fmac_f32 v37, v143, v153
  v_lshlrev_b32 v150, 16, v77
  v_and_b32 v151, s30, v77
  v_lshlrev_b32 v152, 16, v89
  v_and_b32 v153, s30, v89
  v_mul_f32 v38, v38, v148
  v_mul_f32 v39, v39, v148
  v_fmac_f32 v38, v140, v150
  v_fmac_f32 v39, v140, v151
  v_fmac_f32 v38, v143, v152
  v_fmac_f32 v39, v143, v153
  v_lshlrev_b32 v150, 16, v78
  v_and_b32 v151, s30, v78
  v_lshlrev_b32 v152, 16, v90
  v_and_b32 v153, s30, v90
  v_mul_f32 v40, v40, v148
  v_mul_f32 v41, v41, v148
  v_fmac_f32 v40, v140, v150
  v_fmac_f32 v41, v140, v151
  v_fmac_f32 v40, v143, v152
  v_fmac_f32 v41, v143, v153
  v_lshlrev_b32 v150, 16, v79
  v_and_b32 v151, s30, v79
  v_lshlrev_b32 v152, 16, v91
  v_and_b32 v153, s30, v91
  v_mul_f32 v42, v42, v148
  v_mul_f32 v43, v43, v148
  v_fmac_f32 v42, v140, v150
  v_fmac_f32 v43, v140, v151
  v_fmac_f32 v42, v143, v152
  v_fmac_f32 v43, v143, v153
  s_waitcnt vmcnt(6)
  v_dot2_f32_bf16 v140, v92, v6, 0
  v_dot2c_f32_bf16 v140, v93, v7
  v_dot2c_f32_bf16 v140, v94, v8
  v_dot2c_f32_bf16 v140, v95, v9
  v_dot2_f32_bf16 v141, v96, v10, 0
  v_dot2c_f32_bf16 v141, v97, v11
  v_dot2c_f32_bf16 v141, v98, v12
  v_dot2c_f32_bf16 v141, v99, v13
  v_dot2_f32_bf16 v142, v100, v14, 0
  v_dot2c_f32_bf16 v142, v101, v15
  v_dot2c_f32_bf16 v142, v102, v16
  v_dot2c_f32_bf16 v142, v103, v17
  v_dot2_f32_bf16 v143, v104, v6, 0
  v_dot2c_f32_bf16 v143, v105, v7
  v_dot2c_f32_bf16 v143, v106, v8
  v_dot2c_f32_bf16 v143, v107, v9
  v_dot2_f32_bf16 v144, v108, v10, 0
  v_dot2c_f32_bf16 v144, v109, v11
  v_dot2c_f32_bf16 v144, v110, v12
  v_dot2c_f32_bf16 v144, v111, v13
  v_dot2_f32_bf16 v145, v112, v14, 0
  v_dot2c_f32_bf16 v145, v113, v15
  v_dot2c_f32_bf16 v145, v114, v16
  v_dot2c_f32_bf16 v145, v115, v17
  v_add_f32 v140, v140, v141
  v_add_f32 v143, v143, v144
  v_add_f32 v140, v140, v142
  v_add_f32 v143, v143, v145
  s_nop 0
  v_add_f32_dpp v140, v140, v140 quad_perm:[1,0,3,2] row_mask:0xf bank_mask:0xf
  v_add_f32_dpp v143, v143, v143 quad_perm:[1,0,3,2] row_mask:0xf bank_mask:0xf
  s_nop 0
  v_add_f32_dpp v140, v140, v140 quad_perm:[2,3,0,1] row_mask:0xf bank_mask:0xf
  v_add_f32_dpp v143, v143, v143 quad_perm:[2,3,0,1] row_mask:0xf bank_mask:0xf
  s_nop 0
  v_add_f32_dpp v140, v140, v140 row_half_mirror row_mask:0xf bank_mask:0xf
  v_add_f32_dpp v143, v143, v143 row_half_mirror row_mask:0xf bank_mask:0xf
  v_cvt_pk_bf16_f32 v141, v140, v143
  v_lshlrev_b32 v140, 16, v141
  v_and_b32 v143, s30, v141
  v_mul_f32 v140, s22, v140
  v_mul_f32 v143, s22, v143
  v_cvt_pk_bf16_f32 v141, v140, v143
  v_lshlrev_b32 v140, 16, v141
  v_and_b32 v143, s30, v141
  v_max3_f32 v146, v18, v140, v143
  v_mul_f32 v147, s23, v146
  v_fma_f32 v148, v18, s21, v147
  v_fma_f32 v140, v140, s21, v147
  v_fma_f32 v143, v143, s21, v147
  v_exp_f32 v148, v148
  v_exp_f32 v140, v140
  v_exp_f32 v143, v143
  v_mov_b32 v18, v146
  v_fma_f32 v19, v19, v148, v140
  v_add_f32 v19, v19, v143
  s_waitcnt vmcnt(0)
  v_lshlrev_b32 v150, 16, v116
  v_and_b32 v151, s30, v116
  v_lshlrev_b32 v152, 16, v128
  v_and_b32 v153, s30, v128
  v_mul_f32 v20, v20, v148
  v_mul_f32 v21, v21, v148
  v_fmac_f32 v20, v140, v150
  v_fmac_f32 v21, v140, v151
  v_fmac_f32 v20, v143, v152
  v_fmac_f32 v21, v143, v153
  v_lshlrev_b32 v150, 16, v117
  v_and_b32 v151, s30, v117
  v_lshlrev_b32 v152, 16, v129
  v_and_b32 v153, s30, v129
  v_mul_f32 v22, v22, v148
  v_mul_f32 v23, v23, v148
  v_fmac_f32 v22, v140, v150
  v_fmac_f32 v23, v140, v151
  v_fmac_f32 v22, v143, v152
  v_fmac_f32 v23, v143, v153
  v_lshlrev_b32 v150, 16, v118
  v_and_b32 v151, s30, v118
  v_lshlrev_b32 v152, 16, v130
  v_and_b32 v153, s30, v130
  v_mul_f32 v24, v24, v148
  v_mul_f32 v25, v25, v148
  v_fmac_f32 v24, v140, v150
  v_fmac_f32 v25, v140, v151
  v_fmac_f32 v24, v143, v152
  v_fmac_f32 v25, v143, v153
  v_lshlrev_b32 v150, 16, v119
  v_and_b32 v151, s30, v119
  v_lshlrev_b32 v152, 16, v131
  v_and_b32 v153, s30, v131
  v_mul_f32 v26, v26, v148
  v_mul_f32 v27, v27, v148
  v_fmac_f32 v26, v140, v150
  v_fmac_f32 v27, v140, v151
  v_fmac_f32 v26, v143, v152
  v_fmac_f32 v27, v143, v153
  v_lshlrev_b32 v150, 16, v120
  v_and_b32 v151, s30, v120
  v_lshlrev_b32 v152, 16, v132
  v_and_b32 v153, s30, v132
  v_mul_f32 v28, v28, v148
  v_mul_f32 v29, v29, v148
  v_fmac_f32 v28, v140, v150
  v_fmac_f32 v29, v140, v151
  v_fmac_f32 v28, v143, v152
  v_fmac_f32 v29, v143, v153
  v_lshlrev_b32 v150, 16, v121
  v_and_b32 v151, s30, v121
  v_lshlrev_b32 v152, 16, v133
  v_and_b32 v153, s30, v133
  v_mul_f32 v30, v30, v148
  v_mul_f32 v31, v31, v148
  v_fmac_f32 v30, v140, v150
  v_fmac_f32 v31, v140, v151
  v_fmac_f32 v30, v143, v152
  v_fmac_f32 v31, v143, v153
  v_lshlrev_b32 v150, 16, v122
  v_and_b32 v151, s30, v122
  v_lshlrev_b32 v152, 16, v134
  v_and_b32 v153, s30, v134
  v_mul_f32 v32, v32, v148
  v_mul_f32 v33, v33, v148
  v_fmac_f32 v32, v140, v150
  v_fmac_f32 v33, v140, v151
  v_fmac_f32 v32, v143, v152
  v_fmac_f32 v33, v143, v153
  v_lshlrev_b32 v150, 16, v123
  v_and_b32 v151, s30, v123
  v_lshlrev_b32 v152, 16, v135
  v_and_b32 v153, s30, v135
  v_mul_f32 v34, v34, v148
  v_mul_f32 v35, v35, v148
  v_fmac_f32 v34, v140, v150
  v_fmac_f32 v35, v140, v151
  v_fmac_f32 v34, v143, v152
  v_fmac_f32 v35, v143, v153
  v_lshlrev_b32 v150, 16, v124
  v_and_b32 v151, s30, v124
  v_lshlrev_b32 v152, 16, v136
  v_and_b32 v153, s30, v136
  v_mul_f32 v36, v36, v148
  v_mul_f32 v37, v37, v148
  v_fmac_f32 v36, v140, v150
  v_fmac_f32 v37, v140, v151
  v_fmac_f32 v36, v143, v152
  v_fmac_f32 v37, v143, v153
  v_lshlrev_b32 v150, 16, v125
  v_and_b32 v151, s30, v125
  v_lshlrev_b32 v152, 16, v137
  v_and_b32 v153, s30, v137
  v_mul_f32 v38, v38, v148
  v_mul_f32 v39, v39, v148
  v_fmac_f32 v38, v140, v150
  v_fmac_f32 v39, v140, v151
  v_fmac_f32 v38, v143, v152
  v_fmac_f32 v39, v143, v153
  v_lshlrev_b32 v150, 16, v126
  v_and_b32 v151, s30, v126
  v_lshlrev_b32 v152, 16, v138
  v_and_b32 v153, s30, v138
  v_mul_f32 v40, v40, v148
  v_mul_f32 v41, v41, v148
  v_fmac_f32 v40, v140, v150
  v_fmac_f32 v41, v140, v151
  v_fmac_f32 v40, v143, v152
  v_fmac_f32 v41, v143, v153
  v_lshlrev_b32 v150, 16, v127
  v_and_b32 v151, s30, v127
  v_lshlrev_b32 v152, 16, v139
  v_and_b32 v153, s30, v139
  v_mul_f32 v42, v42, v148
  v_mul_f32 v43, v43, v148
  v_fmac_f32 v42, v140, v150
  v_fmac_f32 v43, v140, v151
  v_fmac_f32 v42, v143, v152
  v_fmac_f32 v43, v143, v153
  v_lshrrev_b32 v2, 3, v0
  v_lshlrev_b32 v140, 2, v2
  ds_write_b32 v140, v18
  s_waitcnt lgkmcnt(0)
  s_barrier
  v_mov_b32 v141, 0
  ds_read_b128 v[44:47], v141 offset:0
  ds_read_b128 v[48:51], v141 offset:16
  ds_read_b128 v[52:55], v141 offset:32
  ds_read_b128 v[56:59], v141 offset:48
  ds_read_b128 v[60:63], v141 offset:64
  ds_read_b128 v[64:67], v141 offset:80
  ds_read_b128 v[68:71], v141 offset:96
  ds_read_b128 v[72:75], v141 offset:112
  s_waitcnt lgkmcnt(0)
  v_max3_f32 v142, v44, v45, v46
  v_max3_f32 v142, v142, v47, v48
  v_max3_f32 v142, v142, v49, v50
  v_max3_f32 v142, v142, v51, v52
  v_max3_f32 v142, v142, v53, v54
  v_max3_f32 v142, v142, v55, v56
  v_max3_f32 v142, v142, v57, v58
  v_max3_f32 v142, v142, v59, v60
  v_max3_f32 v142, v142, v61, v62
  v_max3_f32 v142, v142, v63, v64
  v_max3_f32 v142, v142, v65, v66
  v_max3_f32 v142, v142, v67, v68
  v_max3_f32 v142, v142, v69, v70
  v_max3_f32 v142, v142, v71, v72
  v_max3_f32 v142, v142, v73, v74
  v_max_f32 v142, v142, v75
  v_sub_f32 v143, v18, v142
  v_mul_f32 v143, s21, v143
  v_exp_f32 v143, v143
  s_nop 0
  v_mul_f32 v20, v20, v143
  v_mul_f32 v21, v21, v143
  v_mul_f32 v22, v22, v143
  v_mul_f32 v23, v23, v143
  v_mul_f32 v24, v24, v143
  v_mul_f32 v25, v25, v143
  v_mul_f32 v26, v26, v143
  v_mul_f32 v27, v27, v143
  v_mul_f32 v28, v28, v143
  v_mul_f32 v29, v29, v143
  v_mul_f32 v30, v30, v143
  v_mul_f32 v31, v31, v143
  v_mul_f32 v32, v32, v143
  v_mul_f32 v33, v33, v143
  v_mul_f32 v34, v34, v143
  v_mul_f32 v35, v35, v143
  v_mul_f32 v36, v36, v143
  v_mul_f32 v37, v37, v143
  v_mul_f32 v38, v38, v143
  v_mul_f32 v39, v39, v143
  v_mul_f32 v40, v40, v143
  v_mul_f32 v41, v41, v143
  v_mul_f32 v42, v42, v143
  v_mul_f32 v43, v43, v143
  v_mul_f32 v19, v19, v143
  ds_write_b32 v140, v19 offset:128
  v_mul_u32_u24 v144, 768, v2
  v_lshl_add_u32 v144, v4, 5, v144
  ds_write_b128 v144, v[20:23] offset:256
  ds_write_b128 v144, v[24:27] offset:272
  ds_write_b128 v144, v[28:31] offset:512
  ds_write_b128 v144, v[32:35] offset:528
  ds_write_b128 v144, v[36:39] offset:768
  ds_write_b128 v144, v[40:43] offset:784
  s_waitcnt lgkmcnt(0)
  s_barrier
  ds_read_b128 v[44:47], v141 offset:128
  ds_read_b128 v[48:51], v141 offset:144
  ds_read_b128 v[52:55], v141 offset:160
  ds_read_b128 v[56:59], v141 offset:176
  ds_read_b128 v[60:63], v141 offset:192
  ds_read_b128 v[64:67], v141 offset:208
  ds_read_b128 v[68:71], v141 offset:224
  ds_read_b128 v[72:75], v141 offset:240
  v_lshlrev_b32 v145, 2, v0
  v_cmp_gt_u32 vcc, 192, v0
  s_and_saveexec_b64 s[32:33], vcc
  s_cbranch_execz K2_SKIPO
  ds_read_b32 v92, v145 offset:256
  ds_read_b32 v93, v145 offset:1024
  ds_read_b32 v94, v145 offset:1792
  ds_read_b32 v95, v145 offset:2560
  ds_read_b32 v96, v145 offset:3328
  ds_read_b32 v97, v145 offset:4096
  ds_read_b32 v98, v145 offset:4864
  ds_read_b32 v99, v145 offset:5632
  ds_read_b32 v100, v145 offset:6400
  ds_read_b32 v101, v145 offset:7168
  ds_read_b32 v102, v145 offset:7936
  ds_read_b32 v103, v145 offset:8704
  ds_read_b32 v104, v145 offset:9472
  ds_read_b32 v105, v145 offset:10240
  ds_read_b32 v106, v145 offset:11008
  ds_read_b32 v107, v145 offset:11776
  ds_read_b32 v108, v145 offset:12544
  ds_read_b32 v109, v145 offset:13312
  ds_read_b32 v110, v145 offset:14080
  ds_read_b32 v111, v145 offset:14848
  ds_read_b32 v112, v145 offset:15616
  ds_read_b32 v113, v145 offset:16384
  ds_read_b32 v114, v145 offset:17152
  ds_read_b32 v115, v145 offset:17920
  ds_read_b32 v116, v145 offset:18688
  ds_read_b32 v117, v145 offset:19456
  ds_read_b32 v118, v145 offset:20224
  ds_read_b32 v119, v145 offset:20992
  ds_read_b32 v120, v145 offset:21760
  ds_read_b32 v121, v145 offset:22528
  ds_read_b32 v122, v145 offset:23296
  ds_read_b32 v123, v145 offset:24064
  s_waitcnt lgkmcnt(0)
  v_add_f32 v92, v92, v93
  v_add_f32 v92, v92, v94
  v_add_f32 v92, v92, v95
  v_add_f32 v92, v92, v96
  v_add_f32 v92, v92, v97
  v_add_f32 v92, v92, v98
  v_add_f32 v92, v92, v99
  v_add_f32 v92, v92, v100
  v_add_f32 v92, v92, v101
  v_add_f32 v92, v92, v102
  v_add_f32 v92, v92, v103
  v_add_f32 v92, v92, v104
  v_add_f32 v92, v92, v105
  v_add_f32 v92, v92, v106
  v_add_f32 v92, v92, v107
  v_add_f32 v92, v92, v108
  v_add_f32 v92, v92, v109
  v_add_f32 v92, v92, v110
  v_add_f32 v92, v92, v111
  v_add_f32 v92, v92, v112
  v_add_f32 v92, v92, v113
  v_add_f32 v92, v92, v114
  v_add_f32 v92, v92, v115
  v_add_f32 v92, v92, v116
  v_add_f32 v92, v92, v117
  v_add_f32 v92, v92, v118
  v_add_f32 v92, v92, v119
  v_add_f32 v92, v92, v120
  v_add_f32 v92, v92, v121
  v_add_f32 v92, v92, v122
  v_add_f32 v92, v92, v123
  s_mul_i32 s17, s2, 768
  v_add_u32 v145, s17, v145
  s_add_u32 s17, s17, 131072
  v_lshlrev_b32 v145, 2, v0
  buffer_store_dword v92, v145, s[12:15], s17 offen
K2_SKIPO:
  s_mov_b64 exec, s[32:33]
  s_waitcnt lgkmcnt(0)
  v_add_f32 v44, v44, v45
  v_add_f32 v44, v44, v46
  v_add_f32 v44, v44, v47
  v_add_f32 v44, v44, v48
  v_add_f32 v44, v44, v49
  v_add_f32 v44, v44, v50
  v_add_f32 v44, v44, v51
  v_add_f32 v44, v44, v52
  v_add_f32 v44, v44, v53
  v_add_f32 v44, v44, v54
  v_add_f32 v44, v44, v55
  v_add_f32 v44, v44, v56
  v_add_f32 v44, v44, v57
  v_add_f32 v44, v44, v58
  v_add_f32 v44, v44, v59
  v_add_f32 v44, v44, v60
  v_add_f32 v44, v44, v61
  v_add_f32 v44, v44, v62
  v_add_f32 v44, v44, v63
  v_add_f32 v44, v44, v64
  v_add_f32 v44, v44, v65
  v_add_f32 v44, v44, v66
  v_add_f32 v44, v44, v67
  v_add_f32 v44, v44, v68
  v_add_f32 v44, v44, v69
  v_add_f32 v44, v44, v70
  v_add_f32 v44, v44, v71
  v_add_f32 v44, v44, v72
  v_add_f32 v44, v44, v73
  v_add_f32 v44, v44, v74
  v_add_f32 v44, v44, v75
  v_mul_f32 v142, s21, v142
  v_mov_b32 v143, v44
  v_cmp_eq_u32 vcc, 0, v0
  s_and_saveexec_b64 s[32:33], vcc
  s_cbranch_execz K2_END
  s_lshl_b32 s17, s2, 3
  s_add_u32 s17, s17, 65536
  v_mov_b32 v145, 0
  buffer_store_dwordx2 v[142:143], v145, s[12:15], s17 offen
K2_END:
  s_endpgm
.globl proj_kernel
.p2align 8
.type proj_kernel,@function
proj_kernel:
  s_cmp_ge_u32 s2, 160
  s_cbranch_scc1 K3_END
  s_load_dwordx2 s[4:5], s[0:1], 32
  s_load_dwordx2 s[6:7], s[0:1], 64
  s_load_dwordx2 s[8:9], s[0:1], 88
  s_waitcnt lgkmcnt(0)
  s_mov_b32 s12, s8
  s_and_b32 s13, s9, 0xffff
  s_mov_b32 s14, 1610612736
  s_mov_b32 s15, 0x00020000
  s_mov_b32 s16, s4
  s_mov_b32 s17, s5
  s_mov_b32 s18, 7864320
  s_mul_i32 s20, s2, 48
  s_cmp_lt_u32 s2, 128
  s_cbranch_scc1 K3_SEL
  s_mov_b32 s16, s6
  s_mov_b32 s17, s7
  s_mov_b32 s18, 1966080
  s_sub_u32 s20, s2, 128
  s_mul_i32 s20, s20, 48
K3_SEL:
  s_and_b32 s17, s17, 0xffff
  s_mov_b32 s19, 0x00020000
  s_mov_b32 s30, 0xffff0000
  v_cmp_gt_u32 vcc, 48, v0
  s_and_saveexec_b64 s[32:33], vcc
  s_cbranch_execz K3_LATEBULK
  s_mov_b64 s[36:37], exec
  s_cmp_lt_u32 s2, 128
  s_cbranch_scc0 K3_FFN
  s_lshr_b32 s22, s2, 2
  s_and_b32 s23, s2, 3
  s_mul_i32 s23, s23, 48
  s_mul_i32 s24, s22, 128
  s_add_u32 s24, s24, 65536
  v_mov_b32 v2, 0
  buffer_load_dwordx2 v[80:81], v2, s[12:15], s24 offen offset:0
  buffer_load_dwordx2 v[82:83], v2, s[12:15], s24 offen offset:8
  buffer_load_dwordx2 v[84:85], v2, s[12:15], s24 offen offset:16
  buffer_load_dwordx2 v[86:87], v2, s[12:15], s24 offen offset:24
  buffer_load_dwordx2 v[88:89], v2, s[12:15], s24 offen offset:32
  buffer_load_dwordx2 v[90:91], v2, s[12:15], s24 offen offset:40
  buffer_load_dwordx2 v[92:93], v2, s[12:15], s24 offen offset:48
  buffer_load_dwordx2 v[94:95], v2, s[12:15], s24 offen offset:56
  buffer_load_dwordx2 v[96:97], v2, s[12:15], s24 offen offset:64
  buffer_load_dwordx2 v[98:99], v2, s[12:15], s24 offen offset:72
  buffer_load_dwordx2 v[100:101], v2, s[12:15], s24 offen offset:80
  buffer_load_dwordx2 v[102:103], v2, s[12:15], s24 offen offset:88
  buffer_load_dwordx2 v[104:105], v2, s[12:15], s24 offen offset:96
  buffer_load_dwordx2 v[106:107], v2, s[12:15], s24 offen offset:104
  buffer_load_dwordx2 v[108:109], v2, s[12:15], s24 offen offset:112
  buffer_load_dwordx2 v[110:111], v2, s[12:15], s24 offen offset:120
  s_mul_i32 s25, s22, 12288
  s_lshl_b32 s26, s23, 2
  s_add_u32 s25, s25, s26
  s_add_u32 s25, s25, 131072
  v_lshlrev_b32 v3, 2, v0
  buffer_load_dword v112, v3, s[12:15], s25 offen
  s_add_u32 s25, s25, 768
  buffer_load_dword v113, v3, s[12:15], s25 offen
  s_add_u32 s25, s25, 768
  buffer_load_dword v114, v3, s[12:15], s25 offen
  s_add_u32 s25, s25, 768
  buffer_load_dword v115, v3, s[12:15], s25 offen
  s_add_u32 s25, s25, 768
  buffer_load_dword v116, v3, s[12:15], s25 offen
  s_add_u32 s25, s25, 768
  buffer_load_dword v117, v3, s[12:15], s25 offen
  s_add_u32 s25, s25, 768
  buffer_load_dword v118, v3, s[12:15], s25 offen
  s_add_u32 s25, s25, 768
  buffer_load_dword v119, v3, s[12:15], s25 offen
  s_add_u32 s25, s25, 768
  buffer_load_dword v120, v3, s[12:15], s25 offen
  s_add_u32 s25, s25, 768
  buffer_load_dword v121, v3, s[12:15], s25 offen
  s_add_u32 s25, s25, 768
  buffer_load_dword v122, v3, s[12:15], s25 offen
  s_add_u32 s25, s25, 768
  buffer_load_dword v123, v3, s[12:15], s25 offen
  s_add_u32 s25, s25, 768
  buffer_load_dword v124, v3, s[12:15], s25 offen
  s_add_u32 s25, s25, 768
  buffer_load_dword v125, v3, s[12:15], s25 offen
  s_add_u32 s25, s25, 768
  buffer_load_dword v126, v3, s[12:15], s25 offen
  s_add_u32 s25, s25, 768
  buffer_load_dword v127, v3, s[12:15], s25 offen
  s_add_u32 s25, s25, 768
  s_mov_b64 exec, s[32:33]
  v_lshlrev_b32 v1, 4, v0
  s_mul_i32 s21, s20, 1280
  v_cmp_gt_u32 vcc, 240, v0
  s_and_saveexec_b64 s[34:35], vcc
  s_cbranch_execz K3_NOLOADA
  buffer_load_dwordx4 v[16:19], v1, s[16:19], s21 offen
  s_add_u32 s21, s21, 3840
  buffer_load_dwordx4 v[20:23], v1, s[16:19], s21 offen
  s_add_u32 s21, s21, 3840
  buffer_load_dwordx4 v[24:27], v1, s[16:19], s21 offen
  s_add_u32 s21, s21, 3840
  buffer_load_dwordx4 v[28:31], v1, s[16:19], s21 offen
  s_add_u32 s21, s21, 3840
  buffer_load_dwordx4 v[32:35], v1, s[16:19], s21 offen
  s_add_u32 s21, s21, 3840
  buffer_load_dwordx4 v[36:39], v1, s[16:19], s21 offen
  s_add_u32 s21, s21, 3840
  buffer_load_dwordx4 v[40:43], v1, s[16:19], s21 offen
  s_add_u32 s21, s21, 3840
  buffer_load_dwordx4 v[44:47], v1, s[16:19], s21 offen
  s_add_u32 s21, s21, 3840
  buffer_load_dwordx4 v[48:51], v1, s[16:19], s21 offen
  s_add_u32 s21, s21, 3840
  buffer_load_dwordx4 v[52:55], v1, s[16:19], s21 offen
  s_add_u32 s21, s21, 3840
  buffer_load_dwordx4 v[56:59], v1, s[16:19], s21 offen
  s_add_u32 s21, s21, 3840
  buffer_load_dwordx4 v[60:63], v1, s[16:19], s21 offen
  s_add_u32 s21, s21, 3840
  buffer_load_dwordx4 v[64:67], v1, s[16:19], s21 offen
  s_add_u32 s21, s21, 3840
  buffer_load_dwordx4 v[68:71], v1, s[16:19], s21 offen
  s_add_u32 s21, s21, 3840
  buffer_load_dwordx4 v[72:75], v1, s[16:19], s21 offen
  s_add_u32 s21, s21, 3840
  buffer_load_dwordx4 v[76:79], v1, s[16:19], s21 offen
K3_NOLOADA:
  s_mov_b64 exec, s[34:35]
  s_mov_b64 exec, s[36:37]
  s_waitcnt vmcnt(16 + 16)
  v_mov_b32 v4, v80
  v_max_f32 v4, v4, v82
  v_max_f32 v4, v4, v84
  v_max_f32 v4, v4, v86
  v_max_f32 v4, v4, v88
  v_max_f32 v4, v4, v90
  v_max_f32 v4, v4, v92
  v_max_f32 v4, v4, v94
  v_max_f32 v4, v4, v96
  v_max_f32 v4, v4, v98
  v_max_f32 v4, v4, v100
  v_max_f32 v4, v4, v102
  v_max_f32 v4, v4, v104
  v_max_f32 v4, v4, v106
  v_max_f32 v4, v4, v108
  v_max_f32 v4, v4, v110
  v_mov_b32 v5, 0
  v_mov_b32 v6, 0
  v_sub_f32 v7, v80, v4
  v_exp_f32 v7, v7
  s_nop 0
  v_fmac_f32 v5, v7, v81
  s_waitcnt vmcnt(16)
  v_fmac_f32 v6, v7, v112
  v_sub_f32 v7, v82, v4
  v_exp_f32 v7, v7
  s_nop 0
  v_fmac_f32 v5, v7, v83
  v_fmac_f32 v6, v7, v113
  v_sub_f32 v7, v84, v4
  v_exp_f32 v7, v7
  s_nop 0
  v_fmac_f32 v5, v7, v85
  v_fmac_f32 v6, v7, v114
  v_sub_f32 v7, v86, v4
  v_exp_f32 v7, v7
  s_nop 0
  v_fmac_f32 v5, v7, v87
  v_fmac_f32 v6, v7, v115
  v_sub_f32 v7, v88, v4
  v_exp_f32 v7, v7
  s_nop 0
  v_fmac_f32 v5, v7, v89
  v_fmac_f32 v6, v7, v116
  v_sub_f32 v7, v90, v4
  v_exp_f32 v7, v7
  s_nop 0
  v_fmac_f32 v5, v7, v91
  v_fmac_f32 v6, v7, v117
  v_sub_f32 v7, v92, v4
  v_exp_f32 v7, v7
  s_nop 0
  v_fmac_f32 v5, v7, v93
  v_fmac_f32 v6, v7, v118
  v_sub_f32 v7, v94, v4
  v_exp_f32 v7, v7
  s_nop 0
  v_fmac_f32 v5, v7, v95
  v_fmac_f32 v6, v7, v119
  v_sub_f32 v7, v96, v4
  v_exp_f32 v7, v7
  s_nop 0
  v_fmac_f32 v5, v7, v97
  v_fmac_f32 v6, v7, v120
  v_sub_f32 v7, v98, v4
  v_exp_f32 v7, v7
  s_nop 0
  v_fmac_f32 v5, v7, v99
  v_fmac_f32 v6, v7, v121
  v_sub_f32 v7, v100, v4
  v_exp_f32 v7, v7
  s_nop 0
  v_fmac_f32 v5, v7, v101
  v_fmac_f32 v6, v7, v122
  v_sub_f32 v7, v102, v4
  v_exp_f32 v7, v7
  s_nop 0
  v_fmac_f32 v5, v7, v103
  v_fmac_f32 v6, v7, v123
  v_sub_f32 v7, v104, v4
  v_exp_f32 v7, v7
  s_nop 0
  v_fmac_f32 v5, v7, v105
  v_fmac_f32 v6, v7, v124
  v_sub_f32 v7, v106, v4
  v_exp_f32 v7, v7
  s_nop 0
  v_fmac_f32 v5, v7, v107
  v_fmac_f32 v6, v7, v125
  v_sub_f32 v7, v108, v4
  v_exp_f32 v7, v7
  s_nop 0
  v_fmac_f32 v5, v7, v109
  v_fmac_f32 v6, v7, v126
  v_sub_f32 v7, v110, v4
  v_exp_f32 v7, v7
  s_nop 0
  v_fmac_f32 v5, v7, v111
  v_fmac_f32 v6, v7, v127
  v_rcp_f32 v5, v5
  s_nop 0
  v_mul_f32 v6, v6, v5
  v_cvt_pk_bf16_f32 v7, v6, v6
  v_lshlrev_b32 v6, 16, v7
  s_branch K3_VECST
K3_FFN:
  v_lshlrev_b32 v3, 1, v0
  s_lshl_b32 s24, s20, 1
  s_add_u32 s25, s24, 12288
  s_add_u32 s26, s24, 15360
  buffer_load_ushort v4, v3, s[12:15], s25 offen
  buffer_load_ushort v5, v3, s[12:15], s26 offen
  s_mov_b64 exec, s[32:33]
  v_lshlrev_b32 v1, 4, v0
  s_mul_i32 s21, s20, 1280
  v_cmp_gt_u32 vcc, 240, v0
  s_and_saveexec_b64 s[34:35], vcc
  s_cbranch_execz K3_NOLOADB
  buffer_load_dwordx4 v[16:19], v1, s[16:19], s21 offen
  s_add_u32 s21, s21, 3840
  buffer_load_dwordx4 v[20:23], v1, s[16:19], s21 offen
  s_add_u32 s21, s21, 3840
  buffer_load_dwordx4 v[24:27], v1, s[16:19], s21 offen
  s_add_u32 s21, s21, 3840
  buffer_load_dwordx4 v[28:31], v1, s[16:19], s21 offen
  s_add_u32 s21, s21, 3840
  buffer_load_dwordx4 v[32:35], v1, s[16:19], s21 offen
  s_add_u32 s21, s21, 3840
  buffer_load_dwordx4 v[36:39], v1, s[16:19], s21 offen
  s_add_u32 s21, s21, 3840
  buffer_load_dwordx4 v[40:43], v1, s[16:19], s21 offen
  s_add_u32 s21, s21, 3840
  buffer_load_dwordx4 v[44:47], v1, s[16:19], s21 offen
  s_add_u32 s21, s21, 3840
  buffer_load_dwordx4 v[48:51], v1, s[16:19], s21 offen
  s_add_u32 s21, s21, 3840
  buffer_load_dwordx4 v[52:55], v1, s[16:19], s21 offen
  s_add_u32 s21, s21, 3840
  buffer_load_dwordx4 v[56:59], v1, s[16:19], s21 offen
  s_add_u32 s21, s21, 3840
  buffer_load_dwordx4 v[60:63], v1, s[16:19], s21 offen
  s_add_u32 s21, s21, 3840
  buffer_load_dwordx4 v[64:67], v1, s[16:19], s21 offen
  s_add_u32 s21, s21, 3840
  buffer_load_dwordx4 v[68:71], v1, s[16:19], s21 offen
  s_add_u32 s21, s21, 3840
  buffer_load_dwordx4 v[72:75], v1, s[16:19], s21 offen
  s_add_u32 s21, s21, 3840
  buffer_load_dwordx4 v[76:79], v1, s[16:19], s21 offen
K3_NOLOADB:
  s_mov_b64 exec, s[34:35]
  s_mov_b64 exec, s[36:37]
  s_waitcnt vmcnt(16)
  v_lshlrev_b32 v4, 16, v4
  v_lshlrev_b32 v5, 16, v5
  v_mul_f32 v6, 0xbfb8aa3b, v4
  v_exp_f32 v6, v6
  s_nop 0
  v_add_f32 v6, 1.0, v6
  v_rcp_f32 v6, v6
  s_nop 0
  v_mul_f32 v6, v4, v6
  v_cvt_pk_bf16_f32 v7, v6, v6
  v_lshlrev_b32 v6, 16, v7
  v_mul_f32 v6, v6, v5
  v_cvt_pk_bf16_f32 v7, v6, v6
  v_lshlrev_b32 v6, 16, v7
K3_VECST:
  v_lshlrev_b32 v3, 2, v0
  ds_write_b32 v3, v6
  s_branch K3_VECDONE
K3_LATEBULK:
  s_mov_b64 exec, s[32:33]
  v_lshlrev_b32 v1, 4, v0
  s_mul_i32 s21, s20, 1280
  v_cmp_gt_u32 vcc, 240, v0
  s_and_saveexec_b64 s[34:35], vcc
  s_cbranch_execz K3_NOLOADC
  buffer_load_dwordx4 v[16:19], v1, s[16:19], s21 offen
  s_add_u32 s21, s21, 3840
  buffer_load_dwordx4 v[20:23], v1, s[16:19], s21 offen
  s_add_u32 s21, s21, 3840
  buffer_load_dwordx4 v[24:27], v1, s[16:19], s21 offen
  s_add_u32 s21, s21, 3840
  buffer_load_dwordx4 v[28:31], v1, s[16:19], s21 offen
  s_add_u32 s21, s21, 3840
  buffer_load_dwordx4 v[32:35], v1, s[16:19], s21 offen
  s_add_u32 s21, s21, 3840
  buffer_load_dwordx4 v[36:39], v1, s[16:19], s21 offen
  s_add_u32 s21, s21, 3840
  buffer_load_dwordx4 v[40:43], v1, s[16:19], s21 offen
  s_add_u32 s21, s21, 3840
  buffer_load_dwordx4 v[44:47], v1, s[16:19], s21 offen
  s_add_u32 s21, s21, 3840
  buffer_load_dwordx4 v[48:51], v1, s[16:19], s21 offen
  s_add_u32 s21, s21, 3840
  buffer_load_dwordx4 v[52:55], v1, s[16:19], s21 offen
  s_add_u32 s21, s21, 3840
  buffer_load_dwordx4 v[56:59], v1, s[16:19], s21 offen
  s_add_u32 s21, s21, 3840
  buffer_load_dwordx4 v[60:63], v1, s[16:19], s21 offen
  s_add_u32 s21, s21, 3840
  buffer_load_dwordx4 v[64:67], v1, s[16:19], s21 offen
  s_add_u32 s21, s21, 3840
  buffer_load_dwordx4 v[68:71], v1, s[16:19], s21 offen
  s_add_u32 s21, s21, 3840
  buffer_load_dwordx4 v[72:75], v1, s[16:19], s21 offen
  s_add_u32 s21, s21, 3840
  buffer_load_dwordx4 v[76:79], v1, s[16:19], s21 offen
K3_NOLOADC:
  s_mov_b64 exec, s[34:35]
K3_VECDONE:
  s_mov_b64 exec, s[32:33]
  s_waitcnt lgkmcnt(0)
  s_barrier
  v_cmp_gt_u32 vcc, 240, v0
  s_and_saveexec_b64 s[32:33], vcc
  s_cbranch_execz K3_GDONE
  v_cmp_le_u32 vcc, 80, v0
  s_nop 1
  v_cndmask_b32 v2, 0, 4, vcc
  v_cmp_le_u32 vcc, 160, v0
  s_nop 1
  v_cndmask_b32 v2, v2, 8, vcc
  ds_read_b32 v80, v2 offset:0
  ds_read_b32 v81, v2 offset:12
  ds_read_b32 v82, v2 offset:24
  ds_read_b32 v83, v2 offset:36
  ds_read_b32 v84, v2 offset:48
  ds_read_b32 v85, v2 offset:60
  ds_read_b32 v86, v2 offset:72
  ds_read_b32 v87, v2 offset:84
  ds_read_b32 v88, v2 offset:96
  ds_read_b32 v89, v2 offset:108
  ds_read_b32 v90, v2 offset:120
  ds_read_b32 v91, v2 offset:132
  ds_read_b32 v92, v2 offset:144
  ds_read_b32 v93, v2 offset:156
  ds_read_b32 v94, v2 offset:168
  ds_read_b32 v95, v2 offset:180
  v_mov_b32 v4, 0
  v_mov_b32 v5, 0
  v_mov_b32 v6, 0
  v_mov_b32 v7, 0
  v_mov_b32 v8, 0
  v_mov_b32 v9, 0
  v_mov_b32 v10, 0
  v_mov_b32 v11, 0
  s_waitcnt vmcnt(0) lgkmcnt(0)
  v_lshlrev_b32 v12, 16, v16
  v_and_b32 v13, s30, v16
  v_fmac_f32 v4, v12, v80
  v_fmac_f32 v5, v13, v80
  v_lshlrev_b32 v12, 16, v17
  v_and_b32 v13, s30, v17
  v_fmac_f32 v6, v12, v80
  v_fmac_f32 v7, v13, v80
  v_lshlrev_b32 v12, 16, v18
  v_and_b32 v13, s30, v18
  v_fmac_f32 v8, v12, v80
  v_fmac_f32 v9, v13, v80
  v_lshlrev_b32 v12, 16, v19
  v_and_b32 v13, s30, v19
  v_fmac_f32 v10, v12, v80
  v_fmac_f32 v11, v13, v80
  v_lshlrev_b32 v12, 16, v20
  v_and_b32 v13, s30, v20
  v_fmac_f32 v4, v12, v81
  v_fmac_f32 v5, v13, v81
  v_lshlrev_b32 v12, 16, v21
  v_and_b32 v13, s30, v21
  v_fmac_f32 v6, v12, v81
  v_fmac_f32 v7, v13, v81
  v_lshlrev_b32 v12, 16, v22
  v_and_b32 v13, s30, v22
  v_fmac_f32 v8, v12, v81
  v_fmac_f32 v9, v13, v81
  v_lshlrev_b32 v12, 16, v23
  v_and_b32 v13, s30, v23
  v_fmac_f32 v10, v12, v81
  v_fmac_f32 v11, v13, v81
  v_lshlrev_b32 v12, 16, v24
  v_and_b32 v13, s30, v24
  v_fmac_f32 v4, v12, v82
  v_fmac_f32 v5, v13, v82
  v_lshlrev_b32 v12, 16, v25
  v_and_b32 v13, s30, v25
  v_fmac_f32 v6, v12, v82
  v_fmac_f32 v7, v13, v82
  v_lshlrev_b32 v12, 16, v26
  v_and_b32 v13, s30, v26
  v_fmac_f32 v8, v12, v82
  v_fmac_f32 v9, v13, v82
  v_lshlrev_b32 v12, 16, v27
  v_and_b32 v13, s30, v27
  v_fmac_f32 v10, v12, v82
  v_fmac_f32 v11, v13, v82
  v_lshlrev_b32 v12, 16, v28
  v_and_b32 v13, s30, v28
  v_fmac_f32 v4, v12, v83
  v_fmac_f32 v5, v13, v83
  v_lshlrev_b32 v12, 16, v29
  v_and_b32 v13, s30, v29
  v_fmac_f32 v6, v12, v83
  v_fmac_f32 v7, v13, v83
  v_lshlrev_b32 v12, 16, v30
  v_and_b32 v13, s30, v30
  v_fmac_f32 v8, v12, v83
  v_fmac_f32 v9, v13, v83
  v_lshlrev_b32 v12, 16, v31
  v_and_b32 v13, s30, v31
  v_fmac_f32 v10, v12, v83
  v_fmac_f32 v11, v13, v83
  v_lshlrev_b32 v12, 16, v32
  v_and_b32 v13, s30, v32
  v_fmac_f32 v4, v12, v84
  v_fmac_f32 v5, v13, v84
  v_lshlrev_b32 v12, 16, v33
  v_and_b32 v13, s30, v33
  v_fmac_f32 v6, v12, v84
  v_fmac_f32 v7, v13, v84
  v_lshlrev_b32 v12, 16, v34
  v_and_b32 v13, s30, v34
  v_fmac_f32 v8, v12, v84
  v_fmac_f32 v9, v13, v84
  v_lshlrev_b32 v12, 16, v35
  v_and_b32 v13, s30, v35
  v_fmac_f32 v10, v12, v84
  v_fmac_f32 v11, v13, v84
  v_lshlrev_b32 v12, 16, v36
  v_and_b32 v13, s30, v36
  v_fmac_f32 v4, v12, v85
  v_fmac_f32 v5, v13, v85
  v_lshlrev_b32 v12, 16, v37
  v_and_b32 v13, s30, v37
  v_fmac_f32 v6, v12, v85
  v_fmac_f32 v7, v13, v85
  v_lshlrev_b32 v12, 16, v38
  v_and_b32 v13, s30, v38
  v_fmac_f32 v8, v12, v85
  v_fmac_f32 v9, v13, v85
  v_lshlrev_b32 v12, 16, v39
  v_and_b32 v13, s30, v39
  v_fmac_f32 v10, v12, v85
  v_fmac_f32 v11, v13, v85
  v_lshlrev_b32 v12, 16, v40
  v_and_b32 v13, s30, v40
  v_fmac_f32 v4, v12, v86
  v_fmac_f32 v5, v13, v86
  v_lshlrev_b32 v12, 16, v41
  v_and_b32 v13, s30, v41
  v_fmac_f32 v6, v12, v86
  v_fmac_f32 v7, v13, v86
  v_lshlrev_b32 v12, 16, v42
  v_and_b32 v13, s30, v42
  v_fmac_f32 v8, v12, v86
  v_fmac_f32 v9, v13, v86
  v_lshlrev_b32 v12, 16, v43
  v_and_b32 v13, s30, v43
  v_fmac_f32 v10, v12, v86
  v_fmac_f32 v11, v13, v86
  v_lshlrev_b32 v12, 16, v44
  v_and_b32 v13, s30, v44
  v_fmac_f32 v4, v12, v87
  v_fmac_f32 v5, v13, v87
  v_lshlrev_b32 v12, 16, v45
  v_and_b32 v13, s30, v45
  v_fmac_f32 v6, v12, v87
  v_fmac_f32 v7, v13, v87
  v_lshlrev_b32 v12, 16, v46
  v_and_b32 v13, s30, v46
  v_fmac_f32 v8, v12, v87
  v_fmac_f32 v9, v13, v87
  v_lshlrev_b32 v12, 16, v47
  v_and_b32 v13, s30, v47
  v_fmac_f32 v10, v12, v87
  v_fmac_f32 v11, v13, v87
  v_lshlrev_b32 v12, 16, v48
  v_and_b32 v13, s30, v48
  v_fmac_f32 v4, v12, v88
  v_fmac_f32 v5, v13, v88
  v_lshlrev_b32 v12, 16, v49
  v_and_b32 v13, s30, v49
  v_fmac_f32 v6, v12, v88
  v_fmac_f32 v7, v13, v88
  v_lshlrev_b32 v12, 16, v50
  v_and_b32 v13, s30, v50
  v_fmac_f32 v8, v12, v88
  v_fmac_f32 v9, v13, v88
  v_lshlrev_b32 v12, 16, v51
  v_and_b32 v13, s30, v51
  v_fmac_f32 v10, v12, v88
  v_fmac_f32 v11, v13, v88
  v_lshlrev_b32 v12, 16, v52
  v_and_b32 v13, s30, v52
  v_fmac_f32 v4, v12, v89
  v_fmac_f32 v5, v13, v89
  v_lshlrev_b32 v12, 16, v53
  v_and_b32 v13, s30, v53
  v_fmac_f32 v6, v12, v89
  v_fmac_f32 v7, v13, v89
  v_lshlrev_b32 v12, 16, v54
  v_and_b32 v13, s30, v54
  v_fmac_f32 v8, v12, v89
  v_fmac_f32 v9, v13, v89
  v_lshlrev_b32 v12, 16, v55
  v_and_b32 v13, s30, v55
  v_fmac_f32 v10, v12, v89
  v_fmac_f32 v11, v13, v89
  v_lshlrev_b32 v12, 16, v56
  v_and_b32 v13, s30, v56
  v_fmac_f32 v4, v12, v90
  v_fmac_f32 v5, v13, v90
  v_lshlrev_b32 v12, 16, v57
  v_and_b32 v13, s30, v57
  v_fmac_f32 v6, v12, v90
  v_fmac_f32 v7, v13, v90
  v_lshlrev_b32 v12, 16, v58
  v_and_b32 v13, s30, v58
  v_fmac_f32 v8, v12, v90
  v_fmac_f32 v9, v13, v90
  v_lshlrev_b32 v12, 16, v59
  v_and_b32 v13, s30, v59
  v_fmac_f32 v10, v12, v90
  v_fmac_f32 v11, v13, v90
  v_lshlrev_b32 v12, 16, v60
  v_and_b32 v13, s30, v60
  v_fmac_f32 v4, v12, v91
  v_fmac_f32 v5, v13, v91
  v_lshlrev_b32 v12, 16, v61
  v_and_b32 v13, s30, v61
  v_fmac_f32 v6, v12, v91
  v_fmac_f32 v7, v13, v91
  v_lshlrev_b32 v12, 16, v62
  v_and_b32 v13, s30, v62
  v_fmac_f32 v8, v12, v91
  v_fmac_f32 v9, v13, v91
  v_lshlrev_b32 v12, 16, v63
  v_and_b32 v13, s30, v63
  v_fmac_f32 v10, v12, v91
  v_fmac_f32 v11, v13, v91
  v_lshlrev_b32 v12, 16, v64
  v_and_b32 v13, s30, v64
  v_fmac_f32 v4, v12, v92
  v_fmac_f32 v5, v13, v92
  v_lshlrev_b32 v12, 16, v65
  v_and_b32 v13, s30, v65
  v_fmac_f32 v6, v12, v92
  v_fmac_f32 v7, v13, v92
  v_lshlrev_b32 v12, 16, v66
  v_and_b32 v13, s30, v66
  v_fmac_f32 v8, v12, v92
  v_fmac_f32 v9, v13, v92
  v_lshlrev_b32 v12, 16, v67
  v_and_b32 v13, s30, v67
  v_fmac_f32 v10, v12, v92
  v_fmac_f32 v11, v13, v92
  v_lshlrev_b32 v12, 16, v68
  v_and_b32 v13, s30, v68
  v_fmac_f32 v4, v12, v93
  v_fmac_f32 v5, v13, v93
  v_lshlrev_b32 v12, 16, v69
  v_and_b32 v13, s30, v69
  v_fmac_f32 v6, v12, v93
  v_fmac_f32 v7, v13, v93
  v_lshlrev_b32 v12, 16, v70
  v_and_b32 v13, s30, v70
  v_fmac_f32 v8, v12, v93
  v_fmac_f32 v9, v13, v93
  v_lshlrev_b32 v12, 16, v71
  v_and_b32 v13, s30, v71
  v_fmac_f32 v10, v12, v93
  v_fmac_f32 v11, v13, v93
  v_lshlrev_b32 v12, 16, v72
  v_and_b32 v13, s30, v72
  v_fmac_f32 v4, v12, v94
  v_fmac_f32 v5, v13, v94
  v_lshlrev_b32 v12, 16, v73
  v_and_b32 v13, s30, v73
  v_fmac_f32 v6, v12, v94
  v_fmac_f32 v7, v13, v94
  v_lshlrev_b32 v12, 16, v74
  v_and_b32 v13, s30, v74
  v_fmac_f32 v8, v12, v94
  v_fmac_f32 v9, v13, v94
  v_lshlrev_b32 v12, 16, v75
  v_and_b32 v13, s30, v75
  v_fmac_f32 v10, v12, v94
  v_fmac_f32 v11, v13, v94
  v_lshlrev_b32 v12, 16, v76
  v_and_b32 v13, s30, v76
  v_fmac_f32 v4, v12, v95
  v_fmac_f32 v5, v13, v95
  v_lshlrev_b32 v12, 16, v77
  v_and_b32 v13, s30, v77
  v_fmac_f32 v6, v12, v95
  v_fmac_f32 v7, v13, v95
  v_lshlrev_b32 v12, 16, v78
  v_and_b32 v13, s30, v78
  v_fmac_f32 v8, v12, v95
  v_fmac_f32 v9, v13, v95
  v_lshlrev_b32 v12, 16, v79
  v_and_b32 v13, s30, v79
  v_fmac_f32 v10, v12, v95
  v_fmac_f32 v11, v13, v95
  v_lshlrev_b32 v2, 5, v0
  ds_write_b128 v2, v[4:7] offset:256
  ds_write_b128 v2, v[8:11] offset:272
K3_GDONE:
  s_mov_b64 exec, s[32:33]
  s_waitcnt lgkmcnt(0)
  s_barrier
  v_lshlrev_b32 v2, 2, v0
  ds_read_b32 v16, v2 offset:256
  ds_read_b32 v17, v2 offset:2816
  ds_read_b32 v18, v2 offset:5376
  ds_read_b32 v19, v2 offset:1280
  ds_read_b32 v20, v2 offset:3840
  ds_read_b32 v21, v2 offset:6400
  ds_read_b32 v22, v2 offset:2304
  ds_read_b32 v23, v2 offset:4864
  ds_read_b32 v24, v2 offset:7424
  s_waitcnt lgkmcnt(0)
  v_add_f32 v16, v16, v17
  v_add_f32 v16, v16, v18
  v_add_f32 v19, v19, v20
  v_add_f32 v19, v19, v21
  v_add_f32 v22, v22, v23
  v_add_f32 v22, v22, v24
  s_mul_i32 s24, s2, 2560
  s_add_u32 s24, s24, 4194304
  buffer_store_dword v16, v2, s[12:15], s24 offen
  buffer_store_dword v19, v2, s[12:15], s24 offen offset:1024
  v_cmp_gt_u32 vcc, 128, v0
  s_and_saveexec_b64 s[32:33], vcc
  s_cbranch_execz K3_END
  buffer_store_dword v22, v2, s[12:15], s24 offen offset:2048
K3_END:
  s_endpgm
.globl final_kernel
.p2align 8
.type final_kernel,@function
final_kernel:
  s_cmp_ge_u32 s2, 10
  s_cbranch_scc1 K4_END
  s_load_dwordx2 s[4:5], s[0:1], 0
  s_load_dwordx2 s[6:7], s[0:1], 72
  s_load_dwordx2 s[8:9], s[0:1], 88
  v_and_b32 v1, 63, v0
  v_lshrrev_b32 v2, 6, v0
  s_nop 0
  v_readfirstlane_b32 s20, v2
  s_waitcnt lgkmcnt(0)
  s_mov_b32 s12, s8
  s_and_b32 s13, s9, 0xffff
  s_mov_b32 s14, 1610612736
  s_mov_b32 s15, 0x00020000
  s_mov_b32 s16, s4
  s_and_b32 s17, s5, 0xffff
  s_mov_b32 s18, 1280
  s_mov_b32 s19, 0x00020000
  s_mov_b32 s24, s6
  s_and_b32 s25, s7, 0xffff
  s_mov_b32 s26, 1280
  s_mov_b32 s27, 0x00020000
  s_lshl_b32 s21, s2, 8
  v_lshl_add_u32 v3, v1, 2, s21
  s_mul_i32 s22, s20, 32*2560
  s_add_u32 s22, s22, 4194304
  buffer_load_dword v16, v3, s[12:15], s22 offen
  s_add_u32 s22, s22, 2560
  buffer_load_dword v17, v3, s[12:15], s22 offen
  s_add_u32 s22, s22, 2560
  buffer_load_dword v18, v3, s[12:15], s22 offen
  s_add_u32 s22, s22, 2560
  buffer_load_dword v19, v3, s[12:15], s22 offen
  s_add_u32 s22, s22, 2560
  buffer_load_dword v20, v3, s[12:15], s22 offen
  s_add_u32 s22, s22, 2560
  buffer_load_dword v21, v3, s[12:15], s22 offen
  s_add_u32 s22, s22, 2560
  buffer_load_dword v22, v3, s[12:15], s22 offen
  s_add_u32 s22, s22, 2560
  buffer_load_dword v23, v3, s[12:15], s22 offen
  s_add_u32 s22, s22, 2560
  buffer_load_dword v24, v3, s[12:15], s22 offen
  s_add_u32 s22, s22, 2560
  buffer_load_dword v25, v3, s[12:15], s22 offen
  s_add_u32 s22, s22, 2560
  buffer_load_dword v26, v3, s[12:15], s22 offen
  s_add_u32 s22, s22, 2560
  buffer_load_dword v27, v3, s[12:15], s22 offen
  s_add_u32 s22, s22, 2560
  buffer_load_dword v28, v3, s[12:15], s22 offen
  s_add_u32 s22, s22, 2560
  buffer_load_dword v29, v3, s[12:15], s22 offen
  s_add_u32 s22, s22, 2560
  buffer_load_dword v30, v3, s[12:15], s22 offen
  s_add_u32 s22, s22, 2560
  buffer_load_dword v31, v3, s[12:15], s22 offen
  s_add_u32 s22, s22, 2560
  buffer_load_dword v32, v3, s[12:15], s22 offen
  s_add_u32 s22, s22, 2560
  buffer_load_dword v33, v3, s[12:15], s22 offen
  s_add_u32 s22, s22, 2560
  buffer_load_dword v34, v3, s[12:15], s22 offen
  s_add_u32 s22, s22, 2560
  buffer_load_dword v35, v3, s[12:15], s22 offen
  s_add_u32 s22, s22, 2560
  buffer_load_dword v36, v3, s[12:15], s22 offen
  s_add_u32 s22, s22, 2560
  buffer_load_dword v37, v3, s[12:15], s22 offen
  s_add_u32 s22, s22, 2560
  buffer_load_dword v38, v3, s[12:15], s22 offen
  s_add_u32 s22, s22, 2560
  buffer_load_dword v39, v3, s[12:15], s22 offen
  s_add_u32 s22, s22, 2560
  buffer_load_dword v40, v3, s[12:15], s22 offen
  s_add_u32 s22, s22, 2560
  buffer_load_dword v41, v3, s[12:15], s22 offen
  s_add_u32 s22, s22, 2560
  buffer_load_dword v42, v3, s[12:15], s22 offen
  s_add_u32 s22, s22, 2560
  buffer_load_dword v43, v3, s[12:15], s22 offen
  s_add_u32 s22, s22, 2560
  buffer_load_dword v44, v3, s[12:15], s22 offen
  s_add_u32 s22, s22, 2560
  buffer_load_dword v45, v3, s[12:15], s22 offen
  s_add_u32 s22, s22, 2560
  buffer_load_dword v46, v3, s[12:15], s22 offen
  s_add_u32 s22, s22, 2560
  buffer_load_dword v47, v3, s[12:15], s22 offen
  s_add_u32 s22, s22, 2560
  s_mul_i32 s22, s20, 8*2560
  s_add_u32 s22, s22, 4521984
  buffer_load_dword v48, v3, s[12:15], s22 offen
  s_add_u32 s22, s22, 2560
  buffer_load_dword v49, v3, s[12:15], s22 offen
  s_add_u32 s22, s22, 2560
  buffer_load_dword v50, v3, s[12:15], s22 offen
  s_add_u32 s22, s22, 2560
  buffer_load_dword v51, v3, s[12:15], s22 offen
  s_add_u32 s22, s22, 2560
  buffer_load_dword v52, v3, s[12:15], s22 offen
  s_add_u32 s22, s22, 2560
  buffer_load_dword v53, v3, s[12:15], s22 offen
  s_add_u32 s22, s22, 2560
  buffer_load_dword v54, v3, s[12:15], s22 offen
  s_add_u32 s22, s22, 2560
  buffer_load_dword v55, v3, s[12:15], s22 offen
  s_add_u32 s22, s22, 2560
  s_waitcnt vmcnt(8)
  v_add_f32 v16, v16, v17
  v_add_f32 v16, v16, v18
  v_add_f32 v16, v16, v19
  v_add_f32 v16, v16, v20
  v_add_f32 v16, v16, v21
  v_add_f32 v16, v16, v22
  v_add_f32 v16, v16, v23
  v_add_f32 v16, v16, v24
  v_add_f32 v16, v16, v25
  v_add_f32 v16, v16, v26
  v_add_f32 v16, v16, v27
  v_add_f32 v16, v16, v28
  v_add_f32 v16, v16, v29
  v_add_f32 v16, v16, v30
  v_add_f32 v16, v16, v31
  v_add_f32 v16, v16, v32
  v_add_f32 v16, v16, v33
  v_add_f32 v16, v16, v34
  v_add_f32 v16, v16, v35
  v_add_f32 v16, v16, v36
  v_add_f32 v16, v16, v37
  v_add_f32 v16, v16, v38
  v_add_f32 v16, v16, v39
  v_add_f32 v16, v16, v40
  v_add_f32 v16, v16, v41
  v_add_f32 v16, v16, v42
  v_add_f32 v16, v16, v43
  v_add_f32 v16, v16, v44
  v_add_f32 v16, v16, v45
  v_add_f32 v16, v16, v46
  v_add_f32 v16, v16, v47
  s_waitcnt vmcnt(0)
  v_add_f32 v48, v48, v49
  v_add_f32 v48, v48, v50
  v_add_f32 v48, v48, v51
  v_add_f32 v48, v48, v52
  v_add_f32 v48, v48, v53
  v_add_f32 v48, v48, v54
  v_add_f32 v48, v48, v55
  v_lshlrev_b32 v4, 2, v0
  ds_write_b32 v4, v16
  ds_write_b32 v4, v48 offset:1024
  s_waitcnt lgkmcnt(0)
  s_barrier
  v_cmp_gt_u32 vcc, 64, v0
  s_and_saveexec_b64 s[32:33], vcc
  s_cbranch_execz K4_END
  ds_read_b32 v16, v4 offset:0
  ds_read_b32 v20, v4 offset:1024
  ds_read_b32 v17, v4 offset:256
  ds_read_b32 v21, v4 offset:1280
  ds_read_b32 v18, v4 offset:512
  ds_read_b32 v22, v4 offset:1536
  ds_read_b32 v19, v4 offset:768
  ds_read_b32 v23, v4 offset:1792
  s_lshl_b32 s21, s2, 7
  v_lshl_add_u32 v5, v1, 1, s21
  buffer_load_ushort v6, v5, s[16:19], 0 offen
  s_waitcnt lgkmcnt(0)
  v_add_f32 v16, v16, v17
  v_add_f32 v18, v18, v19
  v_add_f32 v16, v16, v18
  v_add_f32 v20, v20, v21
  v_add_f32 v22, v22, v23
  v_add_f32 v20, v20, v22
  v_cvt_pk_bf16_f32 v7, v16, v16
  v_lshlrev_b32 v16, 16, v7
  v_cvt_pk_bf16_f32 v7, v20, v20
  v_lshlrev_b32 v20, 16, v7
  v_mul_f32 v8, 0xbfb8aa3b, v20
  v_exp_f32 v8, v8
  s_nop 0
  v_add_f32 v8, 1.0, v8
  v_rcp_f32 v8, v8
  s_nop 0
  v_mul_f32 v8, v20, v8
  v_cvt_pk_bf16_f32 v7, v8, v8
  v_lshlrev_b32 v8, 16, v7
  v_mul_f32 v8, v16, v8
  v_cvt_pk_bf16_f32 v7, v8, v8
  v_lshlrev_b32 v8, 16, v7
  s_waitcnt vmcnt(0)
  v_lshlrev_b32 v6, 16, v6
  v_add_f32 v8, v6, v8
  v_cvt_pk_bf16_f32 v8, v8, v8
  buffer_store_short v8, v5, s[24:27], 0 offen
K4_END:
  s_endpgm
.section .rodata,"a"
.p2align 6
.amdhsa_kernel prep_kernel
  .amdhsa_next_free_vgpr 144
  .amdhsa_next_free_sgpr 64
  .amdhsa_accum_offset 144
  .amdhsa_group_segment_fixed_size 0
  .amdhsa_kernarg_size 96
  .amdhsa_user_sgpr_count 2
  .amdhsa_user_sgpr_kernarg_segment_ptr 1
  .amdhsa_system_sgpr_workgroup_id_x 1
.end_amdhsa_kernel
.p2align 6
.amdhsa_kernel attn_kernel
  .amdhsa_next_free_vgpr 156
  .amdhsa_next_free_sgpr 64
  .amdhsa_accum_offset 156
  .amdhsa_group_segment_fixed_size 0
  .amdhsa_kernarg_size 96
  .amdhsa_user_sgpr_count 2
  .amdhsa_user_sgpr_kernarg_segment_ptr 1
  .amdhsa_system_sgpr_workgroup_id_x 1
.end_amdhsa_kernel
.p2align 6
.amdhsa_kernel proj_kernel
  .amdhsa_next_free_vgpr 128
  .amdhsa_next_free_sgpr 64
  .amdhsa_accum_offset 128
  .amdhsa_group_segment_fixed_size 0
  .amdhsa_kernarg_size 96
  .amdhsa_user_sgpr_count 2
  .amdhsa_user_sgpr_kernarg_segment_ptr 1
  .amdhsa_system_sgpr_workgroup_id_x 1
.end_amdhsa_kernel
.p2align 6
.amdhsa_kernel final_kernel
  .amdhsa_next_free_vgpr 64
  .amdhsa_next_free_sgpr 64
  .amdhsa_accum_offset 64
  .amdhsa_group_segment_fixed_size 0
  .amdhsa_kernarg_size 96
  .amdhsa_user_sgpr_count 2
  .amdhsa_user_sgpr_kernarg_segment_ptr 1
  .amdhsa_system_sgpr_workgroup_id_x 1
.end_amdhsa_kernel
```
